```python
import torch

def _softmax(x, axis=-1):
    return torch.softmax(x, dim=axis)
def _gelu(x):
    return torch.nn.functional.gelu(x, approximate="tanh")
def _silu(x):
    return torch.nn.functional.silu(x)
def _sigmoid(x):
    return torch.sigmoid(x)
def _layernorm(x, axis=-1, eps=1e-5):
    m = x.mean(dim=axis, keepdim=True)
    v = x.var(dim=axis, keepdim=True, unbiased=False)
    return (x - m) / torch.sqrt(v + eps)
def _scatter_add(tgt, idx, src, axis=0):
    return tgt.clone().index_add_(axis, idx, src)
def _segment_sum(src, seg, n):
    out = torch.zeros((n,) + src.shape[1:], dtype=src.dtype)
    return out.index_add_(0, seg, src)
def _pad(x, pw):
    flat = tuple(v for pair in reversed(pw) for v in pair)
    return torch.nn.functional.pad(x, flat)

kernel_name = 'standalone__gqa_block_cached__near_ridge'

def setup_inputs():

    _w = (lambda a: (lambda t: t.to(torch.bfloat16) if t.is_floating_point() else t)(torch.as_tensor(a)))
    B, Sq, D = 16, 128, 640
    Hq, Hkv, Sk, Dh = 32, 32, 512, 128
    assert Hq % Hkv == 0, (Hq, Hkv)
    return {
        "x": _w((lambda *s: torch.randn(*s, dtype=torch.bfloat16) * 0.8)(B, Sq, D)),
        "k_cache": _w((lambda *s: torch.randn(*s, dtype=torch.bfloat16) * 0.8)(B, Hkv, Sk, Dh)),
        "v_cache": _w((lambda *s: torch.randn(*s, dtype=torch.bfloat16) * 0.05)(B, Hkv, Sk, Dh)),
        "wq": _w((lambda *s: torch.randn(*s, dtype=torch.bfloat16) * 0.8)(D, Hq * Dh) * (D ** -0.5)),
        "wo": _w((lambda *s: torch.randn(*s, dtype=torch.bfloat16) * 0.05)(Hq * Dh, D) * ((Hq * Dh) ** -0.5)),
    }

def reference(x, k_cache, v_cache, wq, wo):
    B, Sq, D = x.shape
    Hq, Dh = 32, 128
    Hkv = k_cache.shape[1]
    rep = Hq // Hkv
    q = (lambda x, *d: x.permute(*d))((x @ wq).reshape(B, Sq, Hq, Dh), 0, 2, 1, 3)
    k = (lambda x, n, axis: torch.repeat_interleave(x, n, dim=axis))(k_cache, rep, axis=1)
    v = (lambda x, n, axis: torch.repeat_interleave(x, n, dim=axis))(v_cache, rep, axis=1)
    scores = torch.einsum("bhqd,bhkd->bhqk", q, k) * (Dh ** -0.5)
    p = _softmax(scores, axis=-1)
    o = torch.einsum("bhqk,bhkd->bhqd", p, v)
    return (lambda x, *d: x.permute(*d))(o, 0, 2, 1, 3).reshape(B, Sq, Hq * Dh) @ wo
```

```asm
; @launch grid=(256,1,1) block=(512,1,1) lds=163840
.amdgcn_target "amdgcn-amd-amdhsa--gfx950"
.text
.globl standalone__gqa_block_cached__near_ridge_kernel
.p2align 8
.type standalone__gqa_block_cached__near_ridge_kernel,@function
standalone__gqa_block_cached__near_ridge_kernel:
    s_cmp_ge_u32 s2, 256
    s_cbranch_scc1 K_END
    s_load_dwordx16 s[64:79], s[0:1], 0
    v_lshrrev_b32 v1, 6, v0
    v_and_b32 v0, 63, v0
    v_readfirstlane_b32 s3, v1
    s_and_b32 s46, s2, 1
    s_lshl_b32 s46, s46, 3
    s_bfe_u32 s48, s2, 0x30003
    s_add_u32 s6, s46, s48
    s_bfe_u32 s42, s2, 0x20001
    s_lshr_b32 s41, s2, 6
    s_lshl2_add_u32 s7, s42, s41
    s_and_b32 s4, s3, 3
    s_lshr_b32 s5, s3, 2
    s_lshl_b32 s45, s4, 10
    s_lshl_b32 s46, s6, 5
    s_add_u32 s46, s46, s7
    s_lshl_b32 s40, s46, 17
    v_lshrrev_b32 v20, 4, v0
    s_lshl_b32 s46, s4, 2
    v_add_u32 v21, s46, v20
    v_and_b32 v22, 15, v0
    v_xor_b32 v23, v22, v21
    v_lshlrev_b32 v23, 4, v23
    v_lshl_add_u32 v1, v21, 8, v23
    v_lshlrev_b32 v23, 2, v20
    v_xor_b32 v23, v22, v23
    v_lshlrev_b32 v23, 4, v23
    v_lshl_add_u32 v2, v21, 8, v23
    s_cmp_lg_u32 s5, 0
    s_cbranch_scc0 G0_START
    s_mul_i32 s49, s41, 5
    s_add_u32 s49, s49, 1
    s_lshr_b32 s49, s49, 1
    s_add_u32 s49, s49, s48
    s_sub_u32 s46, s49, 10
    s_cmp_ge_u32 s49, 10
    s_cselect_b32 s49, s46, s49
    s_lshl_b32 s50, s49, 19
    s_lshl_b32 s51, s49, 7
    v_lshl_add_u32 v3, v21, 13, v23
    s_lshl_b32 s46, s7, 8
    v_add_u32 v3, s46, v3
    s_and_b32 s46, s4, 1
    s_lshl_b32 s46, s46, 2
    v_add_u32 v23, s46, v20
    v_and_b32 v22, 7, v0
    v_xor_b32 v23, v22, v23
    v_lshlrev_b32 v23, 4, v23
    v_lshrrev_b32 v22, 3, v0
    s_lshl_b32 s46, s6, 7
    s_lshl3_add_u32 s46, s4, s46
    v_add_u32 v22, s46, v22
    s_movk_i32 s46, 1280
    v_mul_lo_u32 v22, v22, s46
    v_add_u32 v4, v22, v23
    s_waitcnt lgkmcnt(0)
    s_mov_b32 s20, s70
    s_mov_b32 s21, s71
    s_mov_b32 s22, 0x500000
    s_mov_b32 s23, 0x20000
    s_mov_b32 s8, s64
    s_mov_b32 s9, s65
    s_mov_b32 s10, 0x280000
    s_mov_b32 s11, 0x20000
    s_add_u32 m0, s45, 0x20000
    s_nop 0
    buffer_load_dwordx4 v3, s[20:23], s50 offen lds
    s_add_u32 s50, s50, 0x20000
    s_cmp_eq_u32 s50, 0x500000
    s_cselect_b32 s50, 0, s50
    s_add_u32 m0, s45, 0x21000
    s_nop 0
    buffer_load_dwordx4 v3, s[20:23], s50 offen lds
    s_add_u32 s50, s50, 0x20000
    s_cmp_eq_u32 s50, 0x500000
    s_cselect_b32 s50, 0, s50
    s_add_u32 m0, s45, 0x22000
    s_nop 0
    buffer_load_dwordx4 v3, s[20:23], s50 offen lds
    s_add_u32 s50, s50, 0x20000
    s_cmp_eq_u32 s50, 0x500000
    s_cselect_b32 s50, 0, s50
    s_add_u32 m0, s45, 0x23000
    s_nop 0
    buffer_load_dwordx4 v3, s[20:23], s50 offen lds
    s_add_u32 s50, s50, 0x20000
    s_cmp_eq_u32 s50, 0x500000
    s_cselect_b32 s50, 0, s50
    s_add_u32 s46, s51, 0
    s_add_u32 m0, s45, 0x24000
    s_nop 0
    buffer_load_dwordx4 v4, s[8:11], s46 offen lds
    s_add_u32 s46, s51, 40960
    s_add_u32 m0, s45, 0x25000
    s_nop 0
    buffer_load_dwordx4 v4, s[8:11], s46 offen lds
    s_add_u32 s46, s51, 81920
    s_add_u32 m0, s45, 0x26000
    s_nop 0
    buffer_load_dwordx4 v4, s[8:11], s46 offen lds
    s_add_u32 s46, s51, 122880
    s_add_u32 m0, s45, 0x27000
    s_nop 0
    buffer_load_dwordx4 v4, s[8:11], s46 offen lds
    s_add_u32 s51, s51, 128
    s_cmp_eq_u32 s51, 1280
    s_cselect_b32 s51, 0, s51
    s_add_u32 m0, s45, 0x10000
    s_nop 0
    buffer_load_dwordx4 v3, s[20:23], s50 offen lds
    s_add_u32 s50, s50, 0x20000
    s_cmp_eq_u32 s50, 0x500000
    s_cselect_b32 s50, 0, s50
    s_add_u32 m0, s45, 0x11000
    s_nop 0
    buffer_load_dwordx4 v3, s[20:23], s50 offen lds
    s_add_u32 s50, s50, 0x20000
    s_cmp_eq_u32 s50, 0x500000
    s_cselect_b32 s50, 0, s50
    s_add_u32 m0, s45, 0x12000
    s_nop 0
    buffer_load_dwordx4 v3, s[20:23], s50 offen lds
    s_add_u32 s50, s50, 0x20000
    s_cmp_eq_u32 s50, 0x500000
    s_cselect_b32 s50, 0, s50
    s_add_u32 m0, s45, 0x13000
    s_nop 0
    buffer_load_dwordx4 v3, s[20:23], s50 offen lds
    s_add_u32 s50, s50, 0x20000
    s_cmp_eq_u32 s50, 0x500000
    s_cselect_b32 s50, 0, s50
    s_add_u32 s46, s51, 0
    s_add_u32 m0, s45, 0x14000
    s_nop 0
    buffer_load_dwordx4 v4, s[8:11], s46 offen lds
    s_add_u32 s46, s51, 40960
    s_add_u32 m0, s45, 0x15000
    s_nop 0
    buffer_load_dwordx4 v4, s[8:11], s46 offen lds
    s_add_u32 s46, s51, 81920
    s_add_u32 m0, s45, 0x16000
    s_nop 0
    buffer_load_dwordx4 v4, s[8:11], s46 offen lds
    s_add_u32 s46, s51, 122880
    s_add_u32 m0, s45, 0x17000
    s_nop 0
    buffer_load_dwordx4 v4, s[8:11], s46 offen lds
    s_add_u32 s51, s51, 128
    s_cmp_eq_u32 s51, 1280
    s_cselect_b32 s51, 0, s51
    s_add_u32 m0, s45, 0x18000
    s_nop 0
    buffer_load_dwordx4 v3, s[20:23], s50 offen lds
    s_add_u32 s50, s50, 0x20000
    s_cmp_eq_u32 s50, 0x500000
    s_cselect_b32 s50, 0, s50
    s_add_u32 m0, s45, 0x19000
    s_nop 0
    buffer_load_dwordx4 v3, s[20:23], s50 offen lds
    s_add_u32 s50, s50, 0x20000
    s_cmp_eq_u32 s50, 0x500000
    s_cselect_b32 s50, 0, s50
    s_add_u32 m0, s45, 0x1a000
    s_nop 0
    buffer_load_dwordx4 v3, s[20:23], s50 offen lds
    s_add_u32 s50, s50, 0x20000
    s_cmp_eq_u32 s50, 0x500000
    s_cselect_b32 s50, 0, s50
    s_add_u32 m0, s45, 0x1b000
    s_nop 0
    buffer_load_dwordx4 v3, s[20:23], s50 offen lds
    s_add_u32 s50, s50, 0x20000
    s_cmp_eq_u32 s50, 0x500000
    s_cselect_b32 s50, 0, s50
    s_add_u32 s46, s51, 0
    s_add_u32 m0, s45, 0x1c000
    s_nop 0
    buffer_load_dwordx4 v4, s[8:11], s46 offen lds
    s_add_u32 s46, s51, 40960
    s_add_u32 m0, s45, 0x1d000
    s_nop 0
    buffer_load_dwordx4 v4, s[8:11], s46 offen lds
    s_add_u32 s46, s51, 81920
    s_add_u32 m0, s45, 0x1e000
    s_nop 0
    buffer_load_dwordx4 v4, s[8:11], s46 offen lds
    s_add_u32 s46, s51, 122880
    s_add_u32 m0, s45, 0x1f000
    s_nop 0
    buffer_load_dwordx4 v4, s[8:11], s46 offen lds
    s_add_u32 s51, s51, 128
    s_cmp_eq_u32 s51, 1280
    s_cselect_b32 s51, 0, s51
    s_mov_b32 s12, s66
    s_mov_b32 s13, s67
    s_mov_b32 s14, 0x4000000
    s_mov_b32 s15, 0x20000
    s_mov_b32 s16, s68
    s_mov_b32 s17, s69
    s_mov_b32 s18, 0x4000000
    s_mov_b32 s19, 0x20000
    s_mov_b32 s32, s78
    s_mov_b32 s33, s79
    s_mov_b32 s34, 0x2800000
    s_mov_b32 s35, 0x20000
    s_mov_b32 s24, s72
    s_mov_b32 s25, s73
    s_mov_b32 s26, 0x500000
    s_mov_b32 s27, 0x20000
    s_mov_b32 s28, s74
    s_mov_b32 s29, s75
    s_mov_b32 s30, 0x280000
    s_mov_b32 s31, 0x20000
    s_mov_b32 s36, s76
    s_mov_b32 s37, s77
    s_mov_b32 s38, 0x100
    s_mov_b32 s39, 0x20000
    s_lshl_b32 s56, s6, 21
    s_add_u32 s96, s56, 0x100000
    s_lshl_b32 s46, s42, 17
    s_add_u32 s56, s56, s46
    s_lshl_b32 s46, s4, 13
    s_add_u32 s56, s56, s46
    s_lshl2_add_u32 s46, s41, s4
    s_lshl_b32 s47, s46, 16
    s_add_u32 s96, s96, s47
    s_lshl4_add_u32 s46, s6, s46
    s_mul_i32 s58, s46, 384
    s_add_u32 s58, s58, 0x2000100
    s_lshl2_add_u32 s46, s42, s4
    s_lshl4_add_u32 s46, s6, s46
    s_mul_i32 s57, s46, 384
    s_add_u32 s57, s57, 0x2000000
    s_mul_i32 s59, s42, 655360
    s_mul_i32 s63, s4, 5120
    s_mov_b32 s44, 0x3e0293ee
    v_lshrrev_b32 v20, 5, v0
    v_bfe_u32 v21, v0, 2, 2
    v_lshl_add_u32 v20, v20, 3, v21
    v_lshlrev_b32 v20, 8, v20
    v_lshl_add_u32 v20, v21, 6, v20
    v_bfe_u32 v22, v0, 4, 1
    v_lshl_add_u32 v20, v22, 5, v20
    v_and_b32 v22, 1, v0
    v_lshl_add_u32 v20, v22, 4, v20
    v_bfe_u32 v22, v0, 1, 1
    v_lshl_add_u32 v20, v22, 3, v20
    v_xor_b32 v5, 0, v20
    v_xor_b32 v6, 64, v20
    v_xor_b32 v7, 128, v20
    v_xor_b32 v8, 192, v20
    v_lshlrev_b32 v13, 4, v0
    v_and_b32 v14, 31, v0
    v_bfe_u32 v15, v0, 1, 3
    v_lshlrev_b32 v14, 7, v14
    v_lshl_add_u32 v14, v15, 4, v14
    v_lshrrev_b32 v15, 5, v0
    v_lshlrev_b32 v15, 4, v15
    v_xor_b32 v14, v14, v15
    s_lshl_b32 s46, s4, 12
    s_add_u32 s46, s46, 0x24000
    v_add_u32 v14, s46, v14
    v_xor_b32 v16, 0, v14
    v_xor_b32 v17, 32, v14
    v_xor_b32 v18, 64, v14
    v_xor_b32 v19, 96, v14
    v_add_u32 v9, 0x18000, v5
    v_add_u32 v10, 0x18000, v6
    v_add_u32 v11, 0x18000, v7
    v_add_u32 v12, 0x18000, v8
    s_waitcnt vmcnt(16) lgkmcnt(0)
    s_barrier
    s_add_u32 m0, s45, 0x8000
    s_nop 0
    buffer_load_dwordx4 v3, s[20:23], s50 offen lds
    s_add_u32 s50, s50, 0x20000
    s_cmp_eq_u32 s50, 0x500000
    s_cselect_b32 s50, 0, s50
    s_add_u32 m0, s45, 0x9000
    s_nop 0
    buffer_load_dwordx4 v3, s[20:23], s50 offen lds
    s_add_u32 s50, s50, 0x20000
    s_cmp_eq_u32 s50, 0x500000
    s_cselect_b32 s50, 0, s50
    s_add_u32 m0, s45, 0xa000
    s_nop 0
    buffer_load_dwordx4 v3, s[20:23], s50 offen lds
    s_add_u32 s50, s50, 0x20000
    s_cmp_eq_u32 s50, 0x500000
    s_cselect_b32 s50, 0, s50
    s_add_u32 m0, s45, 0xb000
    s_nop 0
    buffer_load_dwordx4 v3, s[20:23], s50 offen lds
    s_add_u32 s50, s50, 0x20000
    s_cmp_eq_u32 s50, 0x500000
    s_cselect_b32 s50, 0, s50
    s_add_u32 s46, s51, 0
    s_add_u32 m0, s45, 0xc000
    s_nop 0
    buffer_load_dwordx4 v4, s[8:11], s46 offen lds
    s_add_u32 s46, s51, 40960
    s_add_u32 m0, s45, 0xd000
    s_nop 0
    buffer_load_dwordx4 v4, s[8:11], s46 offen lds
    s_add_u32 s46, s51, 81920
    s_add_u32 m0, s45, 0xe000
    s_nop 0
    buffer_load_dwordx4 v4, s[8:11], s46 offen lds
    s_add_u32 s46, s51, 122880
    s_add_u32 m0, s45, 0xf000
    s_nop 0
    buffer_load_dwordx4 v4, s[8:11], s46 offen lds
    s_add_u32 s51, s51, 128
    s_cmp_eq_u32 s51, 1280
    s_cselect_b32 s51, 0, s51
    s_add_u32 s46, s40, 0x0
    s_add_u32 m0, s45, 0x0
    s_nop 0
    buffer_load_dwordx4 v1, s[12:15], s46 offen nt lds
    s_add_u32 s46, s40, 0x1000
    s_add_u32 m0, s45, 0x1000
    s_nop 0
    buffer_load_dwordx4 v1, s[12:15], s46 offen nt lds
    s_add_u32 s46, s40, 0x2000
    s_add_u32 m0, s45, 0x2000
    s_nop 0
    buffer_load_dwordx4 v1, s[12:15], s46 offen nt lds
    s_add_u32 s46, s40, 0x3000
    s_add_u32 m0, s45, 0x3000
    s_nop 0
    buffer_load_dwordx4 v1, s[12:15], s46 offen nt lds
    ds_read_b128 v[96:99], v16
    ds_read_b128 v[100:103], v17
    ds_read_b128 v[104:107], v18
    ds_read_b128 v[108:111], v19
    v_add_u32 v16, 0xffff0000, v16
    v_add_u32 v17, 0xffff0000, v17
    v_add_u32 v18, 0xffff0000, v18
    v_add_u32 v19, 0xffff0000, v19
    s_waitcnt vmcnt(20) lgkmcnt(0)
    s_barrier
    s_add_u32 m0, s45, 0x20000
    s_nop 0
    buffer_load_dwordx4 v3, s[20:23], s50 offen lds
    s_add_u32 s50, s50, 0x20000
    s_cmp_eq_u32 s50, 0x500000
    s_cselect_b32 s50, 0, s50
    s_add_u32 m0, s45, 0x21000
    s_nop 0
    buffer_load_dwordx4 v3, s[20:23], s50 offen lds
    s_add_u32 s50, s50, 0x20000
    s_cmp_eq_u32 s50, 0x500000
    s_cselect_b32 s50, 0, s50
    s_add_u32 m0, s45, 0x22000
    s_nop 0
    buffer_load_dwordx4 v3, s[20:23], s50 offen lds
    s_add_u32 s50, s50, 0x20000
    s_cmp_eq_u32 s50, 0x500000
    s_cselect_b32 s50, 0, s50
    s_add_u32 m0, s45, 0x23000
    s_nop 0
    buffer_load_dwordx4 v3, s[20:23], s50 offen lds
    s_add_u32 s50, s50, 0x20000
    s_cmp_eq_u32 s50, 0x500000
    s_cselect_b32 s50, 0, s50
    s_add_u32 s46, s51, 0
    s_add_u32 m0, s45, 0x24000
    s_nop 0
    buffer_load_dwordx4 v4, s[8:11], s46 offen lds
    s_add_u32 s46, s51, 40960
    s_add_u32 m0, s45, 0x25000
    s_nop 0
    buffer_load_dwordx4 v4, s[8:11], s46 offen lds
    s_add_u32 s46, s51, 81920
    s_add_u32 m0, s45, 0x26000
    s_nop 0
    buffer_load_dwordx4 v4, s[8:11], s46 offen lds
    s_add_u32 s46, s51, 122880
    s_add_u32 m0, s45, 0x27000
    s_nop 0
    buffer_load_dwordx4 v4, s[8:11], s46 offen lds
    s_add_u32 s51, s51, 128
    s_cmp_eq_u32 s51, 1280
    s_cselect_b32 s51, 0, s51
    ds_read_b128 v[112:115], v16
    ds_read_b128 v[116:119], v17
    ds_read_b128 v[120:123], v18
    ds_read_b128 v[124:127], v19
    v_add_u32 v16, 0x8000, v16
    v_add_u32 v17, 0x8000, v17
    v_add_u32 v18, 0x8000, v18
    v_add_u32 v19, 0x8000, v19
    s_waitcnt vmcnt(20) lgkmcnt(0)
    s_barrier
    s_add_u32 m0, s45, 0x10000
    s_nop 0
    buffer_load_dwordx4 v3, s[20:23], s50 offen lds
    s_add_u32 s50, s50, 0x20000
    s_cmp_eq_u32 s50, 0x500000
    s_cselect_b32 s50, 0, s50
    s_add_u32 m0, s45, 0x11000
    s_nop 0
    buffer_load_dwordx4 v3, s[20:23], s50 offen lds
    s_add_u32 s50, s50, 0x20000
    s_cmp_eq_u32 s50, 0x500000
    s_cselect_b32 s50, 0, s50
    s_add_u32 m0, s45, 0x12000
    s_nop 0
    buffer_load_dwordx4 v3, s[20:23], s50 offen lds
    s_add_u32 s50, s50, 0x20000
    s_cmp_eq_u32 s50, 0x500000
    s_cselect_b32 s50, 0, s50
    s_add_u32 m0, s45, 0x13000
    s_nop 0
    buffer_load_dwordx4 v3, s[20:23], s50 offen lds
    s_add_u32 s50, s50, 0x20000
    s_cmp_eq_u32 s50, 0x500000
    s_cselect_b32 s50, 0, s50
    s_add_u32 s46, s51, 0
    s_add_u32 m0, s45, 0x14000
    s_nop 0
    buffer_load_dwordx4 v4, s[8:11], s46 offen lds
    s_add_u32 s46, s51, 40960
    s_add_u32 m0, s45, 0x15000
    s_nop 0
    buffer_load_dwordx4 v4, s[8:11], s46 offen lds
    s_add_u32 s46, s51, 81920
    s_add_u32 m0, s45, 0x16000
    s_nop 0
    buffer_load_dwordx4 v4, s[8:11], s46 offen lds
    s_add_u32 s46, s51, 122880
    s_add_u32 m0, s45, 0x17000
    s_nop 0
    buffer_load_dwordx4 v4, s[8:11], s46 offen lds
    s_add_u32 s51, s51, 128
    s_cmp_eq_u32 s51, 1280
    s_cselect_b32 s51, 0, s51
    v_min_u32 v14, 39, v0
    v_lshrrev_b32 v15, 3, v14
    v_lshlrev_b32 v15, 13, v15
    v_and_b32 v14, 7, v14
    v_lshl_add_u32 v14, v14, 7, v15
    s_lshr_b32 s47, s2, 3
    s_lshl2_add_u32 s47, s47, s4
    s_mul_i32 s47, s47, 40960
    s_lshl_b32 s48, s42, 10
    s_add_u32 s47, s47, s48
    s_add_u32 s47, s47, 0x1000
    buffer_load_dword v24, v14, s[20:23], s47 offen
    ds_read_b128 v[128:131], v16
    ds_read_b128 v[132:135], v17
    ds_read_b128 v[136:139], v18
    ds_read_b128 v[140:143], v19
    v_add_u32 v16, 0xffff0000, v16
    v_add_u32 v17, 0xffff0000, v17
    v_add_u32 v18, 0xffff0000, v18
    v_add_u32 v19, 0xffff0000, v19
    s_waitcnt vmcnt(21) lgkmcnt(0)
    s_barrier
    s_add_u32 m0, s45, 0x18000
    s_nop 0
    buffer_load_dwordx4 v3, s[20:23], s50 offen lds
    s_add_u32 s50, s50, 0x20000
    s_cmp_eq_u32 s50, 0x500000
    s_cselect_b32 s50, 0, s50
    s_add_u32 m0, s45, 0x19000
    s_nop 0
    buffer_load_dwordx4 v3, s[20:23], s50 offen lds
    s_add_u32 s50, s50, 0x20000
    s_cmp_eq_u32 s50, 0x500000
    s_cselect_b32 s50, 0, s50
    s_add_u32 m0, s45, 0x1a000
    s_nop 0
    buffer_load_dwordx4 v3, s[20:23], s50 offen lds
    s_add_u32 s50, s50, 0x20000
    s_cmp_eq_u32 s50, 0x500000
    s_cselect_b32 s50, 0, s50
    s_add_u32 m0, s45, 0x1b000
    s_nop 0
    buffer_load_dwordx4 v3, s[20:23], s50 offen lds
    s_add_u32 s50, s50, 0x20000
    s_cmp_eq_u32 s50, 0x500000
    s_cselect_b32 s50, 0, s50
    s_add_u32 s46, s51, 0
    s_add_u32 m0, s45, 0x1c000
    s_nop 0
    buffer_load_dwordx4 v4, s[8:11], s46 offen lds
    s_add_u32 s46, s51, 40960
    s_add_u32 m0, s45, 0x1d000
    s_nop 0
    buffer_load_dwordx4 v4, s[8:11], s46 offen lds
    s_add_u32 s46, s51, 81920
    s_add_u32 m0, s45, 0x1e000
    s_nop 0
    buffer_load_dwordx4 v4, s[8:11], s46 offen lds
    s_add_u32 s46, s51, 122880
    s_add_u32 m0, s45, 0x1f000
    s_nop 0
    buffer_load_dwordx4 v4, s[8:11], s46 offen lds
    s_add_u32 s51, s51, 128
    s_cmp_eq_u32 s51, 1280
    s_cselect_b32 s51, 0, s51
    ds_read_b128 v[144:147], v16
    ds_read_b128 v[148:151], v17
    ds_read_b128 v[152:155], v18
    ds_read_b128 v[156:159], v19
    v_add_u32 v16, 0x18000, v16
    v_add_u32 v17, 0x18000, v17
    v_add_u32 v18, 0x18000, v18
    v_add_u32 v19, 0x18000, v19
    s_waitcnt vmcnt(17) lgkmcnt(0)
    s_barrier
    s_add_u32 m0, s45, 0x8000
    s_nop 0
    buffer_load_dwordx4 v3, s[20:23], s50 offen lds
    s_add_u32 s50, s50, 0x20000
    s_cmp_eq_u32 s50, 0x500000
    s_cselect_b32 s50, 0, s50
    s_add_u32 m0, s45, 0x9000
    s_nop 0
    buffer_load_dwordx4 v3, s[20:23], s50 offen lds
    s_add_u32 s50, s50, 0x20000
    s_cmp_eq_u32 s50, 0x500000
    s_cselect_b32 s50, 0, s50
    s_add_u32 m0, s45, 0xa000
    s_nop 0
    buffer_load_dwordx4 v3, s[20:23], s50 offen lds
    s_add_u32 s50, s50, 0x20000
    s_cmp_eq_u32 s50, 0x500000
    s_cselect_b32 s50, 0, s50
    s_add_u32 m0, s45, 0xb000
    s_nop 0
    buffer_load_dwordx4 v3, s[20:23], s50 offen lds
    s_add_u32 s50, s50, 0x20000
    s_cmp_eq_u32 s50, 0x500000
    s_cselect_b32 s50, 0, s50
    s_add_u32 s46, s51, 0
    s_add_u32 m0, s45, 0xc000
    s_nop 0
    buffer_load_dwordx4 v4, s[8:11], s46 offen lds
    s_add_u32 s46, s51, 40960
    s_add_u32 m0, s45, 0xd000
    s_nop 0
    buffer_load_dwordx4 v4, s[8:11], s46 offen lds
    s_add_u32 s46, s51, 81920
    s_add_u32 m0, s45, 0xe000
    s_nop 0
    buffer_load_dwordx4 v4, s[8:11], s46 offen lds
    s_add_u32 s46, s51, 122880
    s_add_u32 m0, s45, 0xf000
    s_nop 0
    buffer_load_dwordx4 v4, s[8:11], s46 offen lds
    s_add_u32 s51, s51, 128
    s_cmp_eq_u32 s51, 1280
    s_cselect_b32 s51, 0, s51
    ds_read_b128 v[160:163], v16
    ds_read_b128 v[164:167], v17
    ds_read_b128 v[168:171], v18
    ds_read_b128 v[172:175], v19
    v_add_u32 v16, 0xffff0000, v16
    v_add_u32 v17, 0xffff0000, v17
    v_add_u32 v18, 0xffff0000, v18
    v_add_u32 v19, 0xffff0000, v19
    s_waitcnt vmcnt(17) lgkmcnt(0)
    s_barrier
    s_add_u32 m0, s45, 0x20000
    s_nop 0
    buffer_load_dwordx4 v3, s[20:23], s50 offen lds
    s_add_u32 s50, s50, 0x20000
    s_cmp_eq_u32 s50, 0x500000
    s_cselect_b32 s50, 0, s50
    s_add_u32 m0, s45, 0x21000
    s_nop 0
    buffer_load_dwordx4 v3, s[20:23], s50 offen lds
    s_add_u32 s50, s50, 0x20000
    s_cmp_eq_u32 s50, 0x500000
    s_cselect_b32 s50, 0, s50
    s_add_u32 m0, s45, 0x22000
    s_nop 0
    buffer_load_dwordx4 v3, s[20:23], s50 offen lds
    s_add_u32 s50, s50, 0x20000
    s_cmp_eq_u32 s50, 0x500000
    s_cselect_b32 s50, 0, s50
    s_add_u32 m0, s45, 0x23000
    s_nop 0
    buffer_load_dwordx4 v3, s[20:23], s50 offen lds
    s_add_u32 s50, s50, 0x20000
    s_cmp_eq_u32 s50, 0x500000
    s_cselect_b32 s50, 0, s50
    s_add_u32 s46, s51, 0
    s_add_u32 m0, s45, 0x24000
    s_nop 0
    buffer_load_dwordx4 v4, s[8:11], s46 offen lds
    s_add_u32 s46, s51, 40960
    s_add_u32 m0, s45, 0x25000
    s_nop 0
    buffer_load_dwordx4 v4, s[8:11], s46 offen lds
    s_add_u32 s46, s51, 81920
    s_add_u32 m0, s45, 0x26000
    s_nop 0
    buffer_load_dwordx4 v4, s[8:11], s46 offen lds
    s_add_u32 s46, s51, 122880
    s_add_u32 m0, s45, 0x27000
    s_nop 0
    buffer_load_dwordx4 v4, s[8:11], s46 offen lds
    s_add_u32 s51, s51, 128
    s_cmp_eq_u32 s51, 1280
    s_cselect_b32 s51, 0, s51
    ds_read_b128 v[176:179], v16
    ds_read_b128 v[180:183], v17
    ds_read_b128 v[184:187], v18
    ds_read_b128 v[188:191], v19
    v_add_u32 v16, 0x8000, v16
    v_add_u32 v17, 0x8000, v17
    v_add_u32 v18, 0x8000, v18
    v_add_u32 v19, 0x8000, v19
    s_waitcnt vmcnt(16) lgkmcnt(0)
    s_barrier
    s_add_u32 m0, s45, 0x10000
    s_nop 0
    buffer_load_dwordx4 v3, s[20:23], s50 offen lds
    s_add_u32 s50, s50, 0x20000
    s_cmp_eq_u32 s50, 0x500000
    s_cselect_b32 s50, 0, s50
    s_add_u32 m0, s45, 0x11000
    s_nop 0
    buffer_load_dwordx4 v3, s[20:23], s50 offen lds
    s_add_u32 s50, s50, 0x20000
    s_cmp_eq_u32 s50, 0x500000
    s_cselect_b32 s50, 0, s50
    s_add_u32 m0, s45, 0x12000
    s_nop 0
    buffer_load_dwordx4 v3, s[20:23], s50 offen lds
    s_add_u32 s50, s50, 0x20000
    s_cmp_eq_u32 s50, 0x500000
    s_cselect_b32 s50, 0, s50
    s_add_u32 m0, s45, 0x13000
    s_nop 0
    buffer_load_dwordx4 v3, s[20:23], s50 offen lds
    s_add_u32 s50, s50, 0x20000
    s_cmp_eq_u32 s50, 0x500000
    s_cselect_b32 s50, 0, s50
    s_add_u32 s46, s51, 0
    s_add_u32 m0, s45, 0x14000
    s_nop 0
    buffer_load_dwordx4 v4, s[8:11], s46 offen lds
    s_add_u32 s46, s51, 40960
    s_add_u32 m0, s45, 0x15000
    s_nop 0
    buffer_load_dwordx4 v4, s[8:11], s46 offen lds
    s_add_u32 s46, s51, 81920
    s_add_u32 m0, s45, 0x16000
    s_nop 0
    buffer_load_dwordx4 v4, s[8:11], s46 offen lds
    s_add_u32 s46, s51, 122880
    s_add_u32 m0, s45, 0x17000
    s_nop 0
    buffer_load_dwordx4 v4, s[8:11], s46 offen lds
    s_add_u32 s51, s51, 128
    s_cmp_eq_u32 s51, 1280
    s_cselect_b32 s51, 0, s51
    s_add_u32 s46, s40, 0x8000
    s_add_u32 m0, s45, 0x4000
    s_nop 0
    buffer_load_dwordx4 v2, s[16:19], s46 offen nt lds
    s_add_u32 s46, s40, 0x9000
    s_add_u32 m0, s45, 0x5000
    s_nop 0
    buffer_load_dwordx4 v2, s[16:19], s46 offen nt lds
    s_add_u32 s46, s40, 0xa000
    s_add_u32 m0, s45, 0x6000
    s_nop 0
    buffer_load_dwordx4 v2, s[16:19], s46 offen nt lds
    s_add_u32 s46, s40, 0xb000
    s_add_u32 m0, s45, 0x7000
    s_nop 0
    buffer_load_dwordx4 v2, s[16:19], s46 offen nt lds
    ds_read_b128 v[192:195], v16
    ds_read_b128 v[196:199], v17
    ds_read_b128 v[200:203], v18
    ds_read_b128 v[204:207], v19
    v_add_u32 v16, 0xffff0000, v16
    v_add_u32 v17, 0xffff0000, v17
    v_add_u32 v18, 0xffff0000, v18
    v_add_u32 v19, 0xffff0000, v19
    s_waitcnt vmcnt(20) lgkmcnt(0)
    s_barrier
    v_add_u32 v3, 0x1000, v3
    s_add_u32 m0, s45, 0x18000
    s_nop 0
    buffer_load_dwordx4 v3, s[20:23], s50 offen lds
    s_add_u32 s50, s50, 0x20000
    s_cmp_eq_u32 s50, 0x500000
    s_cselect_b32 s50, 0, s50
    s_add_u32 m0, s45, 0x19000
    s_nop 0
    buffer_load_dwordx4 v3, s[20:23], s50 offen lds
    s_add_u32 s50, s50, 0x20000
    s_cmp_eq_u32 s50, 0x500000
    s_cselect_b32 s50, 0, s50
    s_add_u32 m0, s45, 0x1a000
    s_nop 0
    buffer_load_dwordx4 v3, s[20:23], s50 offen lds
    s_add_u32 s50, s50, 0x20000
    s_cmp_eq_u32 s50, 0x500000
    s_cselect_b32 s50, 0, s50
    s_add_u32 m0, s45, 0x1b000
    s_nop 0
    buffer_load_dwordx4 v3, s[20:23], s50 offen lds
    s_add_u32 s50, s50, 0x20000
    s_cmp_eq_u32 s50, 0x500000
    s_cselect_b32 s50, 0, s50
    ds_read_b128 v[208:211], v16
    ds_read_b128 v[212:215], v17
    ds_read_b128 v[216:219], v18
    ds_read_b128 v[220:223], v19
    v_add_u32 v16, 0x18000, v16
    v_add_u32 v17, 0x18000, v17
    v_add_u32 v18, 0x18000, v18
    v_add_u32 v19, 0x18000, v19
    s_waitcnt vmcnt(16) lgkmcnt(0)
    s_barrier
    s_add_u32 s46, s40, 0x4000
    s_add_u32 m0, s45, 0x8000
    s_nop 0
    buffer_load_dwordx4 v1, s[12:15], s46 offen nt lds
    s_add_u32 s46, s40, 0x5000
    s_add_u32 m0, s45, 0x9000
    s_nop 0
    buffer_load_dwordx4 v1, s[12:15], s46 offen nt lds
    s_add_u32 s46, s40, 0x6000
    s_add_u32 m0, s45, 0xa000
    s_nop 0
    buffer_load_dwordx4 v1, s[12:15], s46 offen nt lds
    s_add_u32 s46, s40, 0x7000
    s_add_u32 m0, s45, 0xb000
    s_nop 0
    buffer_load_dwordx4 v1, s[12:15], s46 offen nt lds
    s_add_u32 s46, s40, 0x0
    s_add_u32 m0, s45, 0xc000
    s_nop 0
    buffer_load_dwordx4 v2, s[16:19], s46 offen nt lds
    s_add_u32 s46, s40, 0x1000
    s_add_u32 m0, s45, 0xd000
    s_nop 0
    buffer_load_dwordx4 v2, s[16:19], s46 offen nt lds
    s_add_u32 s46, s40, 0x2000
    s_add_u32 m0, s45, 0xe000
    s_nop 0
    buffer_load_dwordx4 v2, s[16:19], s46 offen nt lds
    s_add_u32 s46, s40, 0x3000
    s_add_u32 m0, s45, 0xf000
    s_nop 0
    buffer_load_dwordx4 v2, s[16:19], s46 offen nt lds
    ds_read_b128 v[224:227], v16
    ds_read_b128 v[228:231], v17
    ds_read_b128 v[232:235], v18
    ds_read_b128 v[236:239], v19
    v_add_u32 v16, 0xffff0000, v16
    v_add_u32 v17, 0xffff0000, v17
    v_add_u32 v18, 0xffff0000, v18
    v_add_u32 v19, 0xffff0000, v19
    s_waitcnt vmcnt(16) lgkmcnt(0)
    s_barrier
    s_add_u32 m0, s45, 0x20000
    s_nop 0
    buffer_load_dwordx4 v3, s[20:23], s50 offen lds
    s_add_u32 s50, s50, 0x20000
    s_cmp_eq_u32 s50, 0x500000
    s_cselect_b32 s50, 0, s50
    s_add_u32 m0, s45, 0x21000
    s_nop 0
    buffer_load_dwordx4 v3, s[20:23], s50 offen lds
    s_add_u32 s50, s50, 0x20000
    s_cmp_eq_u32 s50, 0x500000
    s_cselect_b32 s50, 0, s50
    s_add_u32 m0, s45, 0x22000
    s_nop 0
    buffer_load_dwordx4 v3, s[20:23], s50 offen lds
    s_add_u32 s50, s50, 0x20000
    s_cmp_eq_u32 s50, 0x500000
    s_cselect_b32 s50, 0, s50
    s_add_u32 m0, s45, 0x23000
    s_nop 0
    buffer_load_dwordx4 v3, s[20:23], s50 offen lds
    s_add_u32 s50, s50, 0x20000
    s_cmp_eq_u32 s50, 0x500000
    s_cselect_b32 s50, 0, s50
    s_add_u32 m0, s45, 0x24000
    s_nop 0
    buffer_load_dwordx4 v3, s[20:23], s50 offen lds
    s_add_u32 s50, s50, 0x20000
    s_cmp_eq_u32 s50, 0x500000
    s_cselect_b32 s50, 0, s50
    s_add_u32 m0, s45, 0x25000
    s_nop 0
    buffer_load_dwordx4 v3, s[20:23], s50 offen lds
    s_add_u32 s50, s50, 0x20000
    s_cmp_eq_u32 s50, 0x500000
    s_cselect_b32 s50, 0, s50
    ds_read_b128 v[240:243], v16
    ds_read_b128 v[244:247], v17
    ds_read_b128 v[248:251], v18
    ds_read_b128 v[252:255], v19
    v_add_u32 v16, 0x8000, v16
    v_add_u32 v17, 0x8000, v17
    v_add_u32 v18, 0x8000, v18
    v_add_u32 v19, 0x8000, v19
    s_waitcnt vmcnt(14) lgkmcnt(0)
    s_barrier
    s_setprio 1
    ds_read_b64_tr_b16 v[80:81], v9 offset:0
    ds_read_b64_tr_b16 v[82:83], v9 offset:1024
    ds_read_b64_tr_b16 v[84:85], v10 offset:0
    ds_read_b64_tr_b16 v[86:87], v10 offset:1024
    ds_read_b64_tr_b16 v[88:89], v11 offset:0
    ds_read_b64_tr_b16 v[90:91], v11 offset:1024
    ds_read_b64_tr_b16 v[92:93], v12 offset:0
    ds_read_b64_tr_b16 v[94:95], v12 offset:1024
    s_waitcnt lgkmcnt(6)
    v_mfma_f32_32x32x16_bf16 v[16:31], v[80:83], v[96:99], 0
    ds_read_b64_tr_b16 v[80:81], v9 offset:4096
    ds_read_b64_tr_b16 v[82:83], v9 offset:5120
    s_waitcnt lgkmcnt(6)
    v_mfma_f32_32x32x16_bf16 v[32:47], v[84:87], v[96:99], 0
    ds_read_b64_tr_b16 v[84:85], v10 offset:4096
    ds_read_b64_tr_b16 v[86:87], v10 offset:5120
    s_waitcnt lgkmcnt(6)
    v_mfma_f32_32x32x16_bf16 v[48:63], v[88:91], v[96:99], 0
    ds_read_b64_tr_b16 v[88:89], v11 offset:4096
    ds_read_b64_tr_b16 v[90:91], v11 offset:5120
    s_waitcnt lgkmcnt(6)
    v_mfma_f32_32x32x16_bf16 v[64:79], v[92:95], v[96:99], 0
    ds_read_b64_tr_b16 v[92:93], v12 offset:4096
    ds_read_b64_tr_b16 v[94:95], v12 offset:5120
    s_waitcnt lgkmcnt(6)
    v_mfma_f32_32x32x16_bf16 v[16:31], v[80:83], v[100:103], v[16:31]
    ds_read_b64_tr_b16 v[80:81], v9 offset:8192
    ds_read_b64_tr_b16 v[82:83], v9 offset:9216
    s_add_u32 s46, s40, 0x8000
    s_add_u32 m0, s45, 0x10000
    s_nop 0
    buffer_load_dwordx4 v1, s[12:15], s46 offen nt lds
    s_add_u32 s46, s40, 0x9000
    s_add_u32 m0, s45, 0x11000
    s_nop 0
    buffer_load_dwordx4 v1, s[12:15], s46 offen nt lds
    s_waitcnt lgkmcnt(6)
    v_mfma_f32_32x32x16_bf16 v[32:47], v[84:87], v[100:103], v[32:47]
    ds_read_b64_tr_b16 v[84:85], v10 offset:8192
    ds_read_b64_tr_b16 v[86:87], v10 offset:9216
    s_add_u32 s46, s40, 0xa000
    s_add_u32 m0, s45, 0x12000
    s_nop 0
    buffer_load_dwordx4 v1, s[12:15], s46 offen nt lds
    s_waitcnt lgkmcnt(6)
    v_mfma_f32_32x32x16_bf16 v[48:63], v[88:91], v[100:103], v[48:63]
    ds_read_b64_tr_b16 v[88:89], v11 offset:8192
    ds_read_b64_tr_b16 v[90:91], v11 offset:9216
    s_add_u32 s46, s40, 0xb000
    s_add_u32 m0, s45, 0x13000
    s_nop 0
    buffer_load_dwordx4 v1, s[12:15], s46 offen nt lds
    s_waitcnt lgkmcnt(6)
    v_mfma_f32_32x32x16_bf16 v[64:79], v[92:95], v[100:103], v[64:79]
    ds_read_b64_tr_b16 v[92:93], v12 offset:8192
    ds_read_b64_tr_b16 v[94:95], v12 offset:9216
    s_add_u32 s46, s40, 0x4000
    s_add_u32 m0, s45, 0x14000
    s_nop 0
    buffer_load_dwordx4 v2, s[16:19], s46 offen nt lds
    s_waitcnt lgkmcnt(6)
    v_mfma_f32_32x32x16_bf16 v[16:31], v[80:83], v[104:107], v[16:31]
    ds_read_b64_tr_b16 v[80:81], v9 offset:12288
    ds_read_b64_tr_b16 v[82:83], v9 offset:13312
    s_add_u32 s46, s40, 0x5000
    s_add_u32 m0, s45, 0x15000
    s_nop 0
    buffer_load_dwordx4 v2, s[16:19], s46 offen nt lds
    s_waitcnt lgkmcnt(6)
    v_mfma_f32_32x32x16_bf16 v[32:47], v[84:87], v[104:107], v[32:47]
    ds_read_b64_tr_b16 v[84:85], v10 offset:12288
    ds_read_b64_tr_b16 v[86:87], v10 offset:13312
    s_add_u32 s46, s40, 0x6000
    s_add_u32 m0, s45, 0x16000
    s_nop 0
    buffer_load_dwordx4 v2, s[16:19], s46 offen nt lds
    s_waitcnt lgkmcnt(6)
    v_mfma_f32_32x32x16_bf16 v[48:63], v[88:91], v[104:107], v[48:63]
    ds_read_b64_tr_b16 v[88:89], v11 offset:12288
    ds_read_b64_tr_b16 v[90:91], v11 offset:13312
    s_add_u32 s46, s40, 0x7000
    s_add_u32 m0, s45, 0x17000
    s_nop 0
    buffer_load_dwordx4 v2, s[16:19], s46 offen nt lds
    s_waitcnt lgkmcnt(6)
    v_mfma_f32_32x32x16_bf16 v[64:79], v[92:95], v[104:107], v[64:79]
    ds_read_b64_tr_b16 v[92:93], v12 offset:12288
    ds_read_b64_tr_b16 v[94:95], v12 offset:13312
    s_waitcnt lgkmcnt(6)
    v_mfma_f32_32x32x16_bf16 v[16:31], v[80:83], v[108:111], v[16:31]
    s_waitcnt lgkmcnt(4)
    v_mfma_f32_32x32x16_bf16 v[32:47], v[84:87], v[108:111], v[32:47]
    s_waitcnt lgkmcnt(2)
    v_mfma_f32_32x32x16_bf16 v[48:63], v[88:91], v[108:111], v[48:63]
    s_waitcnt lgkmcnt(0)
    v_mfma_f32_32x32x16_bf16 v[64:79], v[92:95], v[108:111], v[64:79]
    s_waitcnt vmcnt(8)
    s_barrier
    s_cmp_lg_u32 s4, 0
    s_cbranch_scc1 NO_CNT
    s_lshl_b32 s46, s6, 4
    v_mov_b32 v14, 1
    v_mov_b32 v15, 0
    s_mov_b64 exec, 1
    buffer_atomic_add v14, v15, s[36:39], s46 offen sc1
    s_mov_b64 exec, -1
NO_CNT:
    ds_read_b64_tr_b16 v[80:81], v9 offset:32768
    ds_read_b64_tr_b16 v[82:83], v9 offset:33792
    ds_read_b64_tr_b16 v[84:85], v10 offset:32768
    ds_read_b64_tr_b16 v[86:87], v10 offset:33792
    ds_read_b64_tr_b16 v[88:89], v11 offset:32768
    ds_read_b64_tr_b16 v[90:91], v11 offset:33792
    ds_read_b64_tr_b16 v[92:93], v12 offset:32768
    ds_read_b64_tr_b16 v[94:95], v12 offset:33792
    s_waitcnt lgkmcnt(6)
    v_mfma_f32_32x32x16_bf16 v[16:31], v[80:83], v[112:115], v[16:31]
    ds_read_b64_tr_b16 v[80:81], v9 offset:36864
    ds_read_b64_tr_b16 v[82:83], v9 offset:37888
    s_waitcnt lgkmcnt(6)
    v_mfma_f32_32x32x16_bf16 v[32:47], v[84:87], v[112:115], v[32:47]
    ds_read_b64_tr_b16 v[84:85], v10 offset:36864
    ds_read_b64_tr_b16 v[86:87], v10 offset:37888
    s_waitcnt lgkmcnt(6)
    v_mfma_f32_32x32x16_bf16 v[48:63], v[88:91], v[112:115], v[48:63]
    ds_read_b64_tr_b16 v[88:89], v11 offset:36864
    ds_read_b64_tr_b16 v[90:91], v11 offset:37888
    s_waitcnt lgkmcnt(6)
    v_mfma_f32_32x32x16_bf16 v[64:79], v[92:95], v[112:115], v[64:79]
    ds_read_b64_tr_b16 v[92:93], v12 offset:36864
    ds_read_b64_tr_b16 v[94:95], v12 offset:37888
    s_waitcnt lgkmcnt(6)
    v_mfma_f32_32x32x16_bf16 v[16:31], v[80:83], v[116:119], v[16:31]
    ds_read_b64_tr_b16 v[80:81], v9 offset:40960
    ds_read_b64_tr_b16 v[82:83], v9 offset:41984
    s_add_u32 m0, s45, 0x18000
    s_nop 0
    buffer_load_dwordx4 v3, s[20:23], s50 offen lds
    s_add_u32 s50, s50, 0x20000
    s_cmp_eq_u32 s50, 0x500000
    s_cselect_b32 s50, 0, s50
    s_waitcnt lgkmcnt(6)
    v_mfma_f32_32x32x16_bf16 v[32:47], v[84:87], v[116:119], v[32:47]
    ds_read_b64_tr_b16 v[84:85], v10 offset:40960
    ds_read_b64_tr_b16 v[86:87], v10 offset:41984
    s_add_u32 m0, s45, 0x19000
    s_nop 0
    buffer_load_dwordx4 v3, s[20:23], s50 offen lds
    s_add_u32 s50, s50, 0x20000
    s_cmp_eq_u32 s50, 0x500000
    s_cselect_b32 s50, 0, s50
    s_waitcnt lgkmcnt(6)
    v_mfma_f32_32x32x16_bf16 v[48:63], v[88:91], v[116:119], v[48:63]
    ds_read_b64_tr_b16 v[88:89], v11 offset:40960
    ds_read_b64_tr_b16 v[90:91], v11 offset:41984
    s_add_u32 m0, s45, 0x1a000
    s_nop 0
    buffer_load_dwordx4 v3, s[20:23], s50 offen lds
    s_add_u32 s50, s50, 0x20000
    s_cmp_eq_u32 s50, 0x500000
    s_cselect_b32 s50, 0, s50
    s_waitcnt lgkmcnt(6)
    v_mfma_f32_32x32x16_bf16 v[64:79], v[92:95], v[116:119], v[64:79]
    ds_read_b64_tr_b16 v[92:93], v12 offset:40960
    ds_read_b64_tr_b16 v[94:95], v12 offset:41984
    s_add_u32 m0, s45, 0x1b000
    s_nop 0
    buffer_load_dwordx4 v3, s[20:23], s50 offen lds
    s_add_u32 s50, s50, 0x20000
    s_cmp_eq_u32 s50, 0x500000
    s_cselect_b32 s50, 0, s50
    s_waitcnt lgkmcnt(6)
    v_mfma_f32_32x32x16_bf16 v[16:31], v[80:83], v[120:123], v[16:31]
    ds_read_b64_tr_b16 v[80:81], v9 offset:45056
    ds_read_b64_tr_b16 v[82:83], v9 offset:46080
    s_add_u32 m0, s45, 0x1c000
    s_nop 0
    buffer_load_dwordx4 v3, s[20:23], s50 offen lds
    s_add_u32 s50, s50, 0x20000
    s_cmp_eq_u32 s50, 0x500000
    s_cselect_b32 s50, 0, s50
    s_waitcnt lgkmcnt(6)
    v_mfma_f32_32x32x16_bf16 v[32:47], v[84:87], v[120:123], v[32:47]
    ds_read_b64_tr_b16 v[84:85], v10 offset:45056
    ds_read_b64_tr_b16 v[86:87], v10 offset:46080
    s_waitcnt lgkmcnt(6)
    v_mfma_f32_32x32x16_bf16 v[48:63], v[88:91], v[120:123], v[48:63]
    ds_read_b64_tr_b16 v[88:89], v11 offset:45056
    ds_read_b64_tr_b16 v[90:91], v11 offset:46080
    s_add_u32 m0, s45, 0x1d000
    s_nop 0
    buffer_load_dwordx4 v3, s[20:23], s50 offen lds
    s_add_u32 s50, s50, 0x20000
    s_cmp_eq_u32 s50, 0x500000
    s_cselect_b32 s50, 0, s50
    s_waitcnt lgkmcnt(6)
    v_mfma_f32_32x32x16_bf16 v[64:79], v[92:95], v[120:123], v[64:79]
    ds_read_b64_tr_b16 v[92:93], v12 offset:45056
    ds_read_b64_tr_b16 v[94:95], v12 offset:46080
    s_add_u32 s46, s40, 0xc000
    s_add_u32 m0, s45, 0x0
    s_nop 0
    buffer_load_dwordx4 v1, s[12:15], s46 offen nt lds
    s_waitcnt lgkmcnt(6)
    v_mfma_f32_32x32x16_bf16 v[16:31], v[80:83], v[124:127], v[16:31]
    ds_read_b64_tr_b16 v[80:81], v9 offset:49152
    ds_read_b64_tr_b16 v[82:83], v9 offset:50176
    s_add_u32 s46, s40, 0xd000
    s_add_u32 m0, s45, 0x1000
    s_nop 0
    buffer_load_dwordx4 v1, s[12:15], s46 offen nt lds
    s_waitcnt lgkmcnt(6)
    v_mfma_f32_32x32x16_bf16 v[32:47], v[84:87], v[124:127], v[32:47]
    ds_read_b64_tr_b16 v[84:85], v10 offset:49152
    ds_read_b64_tr_b16 v[86:87], v10 offset:50176
    s_add_u32 s46, s40, 0xe000
    s_add_u32 m0, s45, 0x2000
    s_nop 0
    buffer_load_dwordx4 v1, s[12:15], s46 offen nt lds
    s_waitcnt lgkmcnt(6)
    v_mfma_f32_32x32x16_bf16 v[48:63], v[88:91], v[124:127], v[48:63]
    ds_read_b64_tr_b16 v[88:89], v11 offset:49152
    ds_read_b64_tr_b16 v[90:91], v11 offset:50176
    s_add_u32 s46, s40, 0xf000
    s_add_u32 m0, s45, 0x3000
    s_nop 0
    buffer_load_dwordx4 v1, s[12:15], s46 offen nt lds
    s_waitcnt lgkmcnt(6)
    v_mfma_f32_32x32x16_bf16 v[64:79], v[92:95], v[124:127], v[64:79]
    ds_read_b64_tr_b16 v[92:93], v12 offset:49152
    ds_read_b64_tr_b16 v[94:95], v12 offset:50176
    s_waitcnt lgkmcnt(6)
    v_mfma_f32_32x32x16_bf16 v[16:31], v[80:83], v[128:131], v[16:31]
    ds_read_b64_tr_b16 v[80:81], v9 offset:53248
    ds_read_b64_tr_b16 v[82:83], v9 offset:54272
    s_waitcnt lgkmcnt(6)
    v_mfma_f32_32x32x16_bf16 v[32:47], v[84:87], v[128:131], v[32:47]
    ds_read_b64_tr_b16 v[84:85], v10 offset:53248
    ds_read_b64_tr_b16 v[86:87], v10 offset:54272
    s_waitcnt lgkmcnt(6)
    v_mfma_f32_32x32x16_bf16 v[48:63], v[88:91], v[128:131], v[48:63]
    ds_read_b64_tr_b16 v[88:89], v11 offset:53248
    ds_read_b64_tr_b16 v[90:91], v11 offset:54272
    s_waitcnt lgkmcnt(6)
    v_mfma_f32_32x32x16_bf16 v[64:79], v[92:95], v[128:131], v[64:79]
    ds_read_b64_tr_b16 v[92:93], v12 offset:53248
    ds_read_b64_tr_b16 v[94:95], v12 offset:54272
    s_waitcnt lgkmcnt(6)
    v_mfma_f32_32x32x16_bf16 v[16:31], v[80:83], v[132:135], v[16:31]
    s_waitcnt lgkmcnt(4)
    v_mfma_f32_32x32x16_bf16 v[32:47], v[84:87], v[132:135], v[32:47]
    s_waitcnt lgkmcnt(2)
    v_mfma_f32_32x32x16_bf16 v[48:63], v[88:91], v[132:135], v[48:63]
    s_waitcnt lgkmcnt(0)
    v_mfma_f32_32x32x16_bf16 v[64:79], v[92:95], v[132:135], v[64:79]
    s_waitcnt vmcnt(4)
    s_barrier
    ds_read_b64_tr_b16 v[80:81], v9 offset:0
    ds_read_b64_tr_b16 v[82:83], v9 offset:1024
    ds_read_b64_tr_b16 v[84:85], v10 offset:0
    ds_read_b64_tr_b16 v[86:87], v10 offset:1024
    ds_read_b64_tr_b16 v[88:89], v11 offset:0
    ds_read_b64_tr_b16 v[90:91], v11 offset:1024
    ds_read_b64_tr_b16 v[92:93], v12 offset:0
    ds_read_b64_tr_b16 v[94:95], v12 offset:1024
    s_waitcnt lgkmcnt(6)
    v_mfma_f32_32x32x16_bf16 v[16:31], v[80:83], v[136:139], v[16:31]
    ds_read_b64_tr_b16 v[80:81], v9 offset:4096
    ds_read_b64_tr_b16 v[82:83], v9 offset:5120
    s_waitcnt lgkmcnt(6)
    v_mfma_f32_32x32x16_bf16 v[32:47], v[84:87], v[136:139], v[32:47]
    ds_read_b64_tr_b16 v[84:85], v10 offset:4096
    ds_read_b64_tr_b16 v[86:87], v10 offset:5120
    s_waitcnt lgkmcnt(6)
    v_mfma_f32_32x32x16_bf16 v[48:63], v[88:91], v[136:139], v[48:63]
    ds_read_b64_tr_b16 v[88:89], v11 offset:4096
    ds_read_b64_tr_b16 v[90:91], v11 offset:5120
    s_waitcnt lgkmcnt(6)
    v_mfma_f32_32x32x16_bf16 v[64:79], v[92:95], v[136:139], v[64:79]
    ds_read_b64_tr_b16 v[92:93], v12 offset:4096
    ds_read_b64_tr_b16 v[94:95], v12 offset:5120
    s_waitcnt lgkmcnt(6)
    v_mfma_f32_32x32x16_bf16 v[16:31], v[80:83], v[140:143], v[16:31]
    ds_read_b64_tr_b16 v[80:81], v9 offset:8192
    ds_read_b64_tr_b16 v[82:83], v9 offset:9216
    s_add_u32 m0, s45, 0x20000
    s_nop 0
    buffer_load_dwordx4 v3, s[20:23], s50 offen lds
    s_add_u32 s50, s50, 0x20000
    s_cmp_eq_u32 s50, 0x500000
    s_cselect_b32 s50, 0, s50
    s_add_u32 m0, s45, 0x21000
    s_nop 0
    buffer_load_dwordx4 v3, s[20:23], s50 offen lds
    s_add_u32 s50, s50, 0x20000
    s_cmp_eq_u32 s50, 0x500000
    s_cselect_b32 s50, 0, s50
    s_waitcnt lgkmcnt(6)
    v_mfma_f32_32x32x16_bf16 v[32:47], v[84:87], v[140:143], v[32:47]
    ds_read_b64_tr_b16 v[84:85], v10 offset:8192
    ds_read_b64_tr_b16 v[86:87], v10 offset:9216
    s_add_u32 m0, s45, 0x22000
    s_nop 0
    buffer_load_dwordx4 v3, s[20:23], s50 offen lds
    s_add_u32 s50, s50, 0x20000
    s_cmp_eq_u32 s50, 0x500000
    s_cselect_b32 s50, 0, s50
    s_waitcnt lgkmcnt(6)
    v_mfma_f32_32x32x16_bf16 v[48:63], v[88:91], v[140:143], v[48:63]
    ds_read_b64_tr_b16 v[88:89], v11 offset:8192
    ds_read_b64_tr_b16 v[90:91], v11 offset:9216
    s_add_u32 m0, s45, 0x23000
    s_nop 0
    buffer_load_dwordx4 v3, s[20:23], s50 offen lds
    s_add_u32 s50, s50, 0x20000
    s_cmp_eq_u32 s50, 0x500000
    s_cselect_b32 s50, 0, s50
    s_waitcnt lgkmcnt(6)
    v_mfma_f32_32x32x16_bf16 v[64:79], v[92:95], v[140:143], v[64:79]
    ds_read_b64_tr_b16 v[92:93], v12 offset:8192
    ds_read_b64_tr_b16 v[94:95], v12 offset:9216
    s_add_u32 m0, s45, 0x24000
    s_nop 0
    buffer_load_dwordx4 v3, s[20:23], s50 offen lds
    s_add_u32 s50, s50, 0x20000
    s_cmp_eq_u32 s50, 0x500000
    s_cselect_b32 s50, 0, s50
    s_waitcnt lgkmcnt(6)
    v_mfma_f32_32x32x16_bf16 v[16:31], v[80:83], v[144:147], v[16:31]
    ds_read_b64_tr_b16 v[80:81], v9 offset:12288
    ds_read_b64_tr_b16 v[82:83], v9 offset:13312
    s_add_u32 m0, s45, 0x25000
    s_nop 0
    buffer_load_dwordx4 v3, s[20:23], s50 offen lds
    s_add_u32 s50, s50, 0x20000
    s_cmp_eq_u32 s50, 0x500000
    s_cselect_b32 s50, 0, s50
    s_waitcnt lgkmcnt(6)
    v_mfma_f32_32x32x16_bf16 v[32:47], v[84:87], v[144:147], v[32:47]
    ds_read_b64_tr_b16 v[84:85], v10 offset:12288
    ds_read_b64_tr_b16 v[86:87], v10 offset:13312
    s_add_u32 s46, s40, 0x10000
    s_add_u32 m0, s45, 0x8000
    s_nop 0
    buffer_load_dwordx4 v1, s[12:15], s46 offen nt lds
    s_waitcnt lgkmcnt(6)
    v_mfma_f32_32x32x16_bf16 v[48:63], v[88:91], v[144:147], v[48:63]
    ds_read_b64_tr_b16 v[88:89], v11 offset:12288
    ds_read_b64_tr_b16 v[90:91], v11 offset:13312
    s_add_u32 s46, s40, 0x11000
    s_add_u32 m0, s45, 0x9000
    s_nop 0
    buffer_load_dwordx4 v1, s[12:15], s46 offen nt lds
    s_add_u32 s46, s40, 0x12000
    s_add_u32 m0, s45, 0xa000
    s_nop 0
    buffer_load_dwordx4 v1, s[12:15], s46 offen nt lds
    s_waitcnt lgkmcnt(6)
    v_mfma_f32_32x32x16_bf16 v[64:79], v[92:95], v[144:147], v[64:79]
    ds_read_b64_tr_b16 v[92:93], v12 offset:12288
    ds_read_b64_tr_b16 v[94:95], v12 offset:13312
    s_add_u32 s46, s40, 0x13000
    s_add_u32 m0, s45, 0xb000
    s_nop 0
    buffer_load_dwordx4 v1, s[12:15], s46 offen nt lds
    s_waitcnt lgkmcnt(6)
    v_mfma_f32_32x32x16_bf16 v[16:31], v[80:83], v[148:151], v[16:31]
    ds_read_b64_tr_b16 v[80:81], v9 offset:16384
    ds_read_b64_tr_b16 v[82:83], v9 offset:17408
    s_add_u32 s46, s40, 0xc000
    s_add_u32 m0, s45, 0xc000
    s_nop 0
    buffer_load_dwordx4 v2, s[16:19], s46 offen nt lds
    s_waitcnt lgkmcnt(6)
    v_mfma_f32_32x32x16_bf16 v[32:47], v[84:87], v[148:151], v[32:47]
    ds_read_b64_tr_b16 v[84:85], v10 offset:16384
    ds_read_b64_tr_b16 v[86:87], v10 offset:17408
    s_add_u32 s46, s40, 0xd000
    s_add_u32 m0, s45, 0xd000
    s_nop 0
    buffer_load_dwordx4 v2, s[16:19], s46 offen nt lds
    s_waitcnt lgkmcnt(6)
    v_mfma_f32_32x32x16_bf16 v[48:63], v[88:91], v[148:151], v[48:63]
    ds_read_b64_tr_b16 v[88:89], v11 offset:16384
    ds_read_b64_tr_b16 v[90:91], v11 offset:17408
    s_add_u32 s46, s40, 0xe000
    s_add_u32 m0, s45, 0xe000
    s_nop 0
    buffer_load_dwordx4 v2, s[16:19], s46 offen nt lds
    s_waitcnt lgkmcnt(6)
    v_mfma_f32_32x32x16_bf16 v[64:79], v[92:95], v[148:151], v[64:79]
    ds_read_b64_tr_b16 v[92:93], v12 offset:16384
    ds_read_b64_tr_b16 v[94:95], v12 offset:17408
    s_add_u32 s46, s40, 0xf000
    s_add_u32 m0, s45, 0xf000
    s_nop 0
    buffer_load_dwordx4 v2, s[16:19], s46 offen nt lds
    s_waitcnt lgkmcnt(6)
    v_mfma_f32_32x32x16_bf16 v[16:31], v[80:83], v[152:155], v[16:31]
    ds_read_b64_tr_b16 v[80:81], v9 offset:20480
    ds_read_b64_tr_b16 v[82:83], v9 offset:21504
    s_waitcnt lgkmcnt(6)
    v_mfma_f32_32x32x16_bf16 v[32:47], v[84:87], v[152:155], v[32:47]
    ds_read_b64_tr_b16 v[84:85], v10 offset:20480
    ds_read_b64_tr_b16 v[86:87], v10 offset:21504
    s_waitcnt lgkmcnt(6)
    v_mfma_f32_32x32x16_bf16 v[48:63], v[88:91], v[152:155], v[48:63]
    ds_read_b64_tr_b16 v[88:89], v11 offset:20480
    ds_read_b64_tr_b16 v[90:91], v11 offset:21504
    s_waitcnt lgkmcnt(6)
    v_mfma_f32_32x32x16_bf16 v[64:79], v[92:95], v[152:155], v[64:79]
    ds_read_b64_tr_b16 v[92:93], v12 offset:20480
    ds_read_b64_tr_b16 v[94:95], v12 offset:21504
    s_waitcnt lgkmcnt(6)
    v_mfma_f32_32x32x16_bf16 v[16:31], v[80:83], v[156:159], v[16:31]
    s_waitcnt lgkmcnt(4)
    v_mfma_f32_32x32x16_bf16 v[32:47], v[84:87], v[156:159], v[32:47]
    s_waitcnt lgkmcnt(2)
    v_mfma_f32_32x32x16_bf16 v[48:63], v[88:91], v[156:159], v[48:63]
    s_waitcnt lgkmcnt(0)
    v_mfma_f32_32x32x16_bf16 v[64:79], v[92:95], v[156:159], v[64:79]
    s_waitcnt vmcnt(8)
    s_barrier
    ds_read_b64_tr_b16 v[80:81], v9 offset:32768
    ds_read_b64_tr_b16 v[82:83], v9 offset:33792
    ds_read_b64_tr_b16 v[84:85], v10 offset:32768
    ds_read_b64_tr_b16 v[86:87], v10 offset:33792
    ds_read_b64_tr_b16 v[88:89], v11 offset:32768
    ds_read_b64_tr_b16 v[90:91], v11 offset:33792
    ds_read_b64_tr_b16 v[92:93], v12 offset:32768
    ds_read_b64_tr_b16 v[94:95], v12 offset:33792
    s_waitcnt lgkmcnt(6)
    v_mfma_f32_32x32x16_bf16 v[16:31], v[80:83], v[160:163], v[16:31]
    ds_read_b64_tr_b16 v[80:81], v9 offset:36864
    ds_read_b64_tr_b16 v[82:83], v9 offset:37888
    s_waitcnt lgkmcnt(6)
    v_mfma_f32_32x32x16_bf16 v[32:47], v[84:87], v[160:163], v[32:47]
    ds_read_b64_tr_b16 v[84:85], v10 offset:36864
    ds_read_b64_tr_b16 v[86:87], v10 offset:37888
    s_waitcnt lgkmcnt(6)
    v_mfma_f32_32x32x16_bf16 v[48:63], v[88:91], v[160:163], v[48:63]
    ds_read_b64_tr_b16 v[88:89], v11 offset:36864
    ds_read_b64_tr_b16 v[90:91], v11 offset:37888
    s_waitcnt lgkmcnt(6)
    v_mfma_f32_32x32x16_bf16 v[64:79], v[92:95], v[160:163], v[64:79]
    ds_read_b64_tr_b16 v[92:93], v12 offset:36864
    ds_read_b64_tr_b16 v[94:95], v12 offset:37888
    s_waitcnt lgkmcnt(6)
    v_mfma_f32_32x32x16_bf16 v[16:31], v[80:83], v[164:167], v[16:31]
    ds_read_b64_tr_b16 v[80:81], v9 offset:40960
    ds_read_b64_tr_b16 v[82:83], v9 offset:41984
    s_add_u32 m0, s45, 0x18000
    s_nop 0
    buffer_load_dwordx4 v3, s[20:23], s50 offen lds
    s_add_u32 s50, s50, 0x20000
    s_cmp_eq_u32 s50, 0x500000
    s_cselect_b32 s50, 0, s50
    s_add_u32 m0, s45, 0x19000
    s_nop 0
    buffer_load_dwordx4 v3, s[20:23], s50 offen lds
    s_add_u32 s50, s50, 0x20000
    s_cmp_eq_u32 s50, 0x500000
    s_cselect_b32 s50, 0, s50
    s_waitcnt lgkmcnt(6)
    v_mfma_f32_32x32x16_bf16 v[32:47], v[84:87], v[164:167], v[32:47]
    ds_read_b64_tr_b16 v[84:85], v10 offset:40960
    ds_read_b64_tr_b16 v[86:87], v10 offset:41984
    s_add_u32 m0, s45, 0x1a000
    s_nop 0
    buffer_load_dwordx4 v3, s[20:23], s50 offen lds
    s_add_u32 s50, s50, 0x20000
    s_cmp_eq_u32 s50, 0x500000
    s_cselect_b32 s50, 0, s50
    s_waitcnt lgkmcnt(6)
    v_mfma_f32_32x32x16_bf16 v[48:63], v[88:91], v[164:167], v[48:63]
    ds_read_b64_tr_b16 v[88:89], v11 offset:40960
    ds_read_b64_tr_b16 v[90:91], v11 offset:41984
    s_add_u32 m0, s45, 0x1b000
    s_nop 0
    buffer_load_dwordx4 v3, s[20:23], s50 offen lds
    s_add_u32 s50, s50, 0x20000
    s_cmp_eq_u32 s50, 0x500000
    s_cselect_b32 s50, 0, s50
    s_waitcnt lgkmcnt(6)
    v_mfma_f32_32x32x16_bf16 v[64:79], v[92:95], v[164:167], v[64:79]
    ds_read_b64_tr_b16 v[92:93], v12 offset:40960
    ds_read_b64_tr_b16 v[94:95], v12 offset:41984
    s_add_u32 m0, s45, 0x1c000
    s_nop 0
    buffer_load_dwordx4 v3, s[20:23], s50 offen lds
    s_add_u32 s50, s50, 0x20000
    s_cmp_eq_u32 s50, 0x500000
    s_cselect_b32 s50, 0, s50
    s_waitcnt lgkmcnt(6)
    v_mfma_f32_32x32x16_bf16 v[16:31], v[80:83], v[168:171], v[16:31]
    ds_read_b64_tr_b16 v[80:81], v9 offset:45056
    ds_read_b64_tr_b16 v[82:83], v9 offset:46080
    s_add_u32 s46, s40, 0x14000
    s_add_u32 m0, s45, 0x10000
    s_nop 0
    buffer_load_dwordx4 v1, s[12:15], s46 offen nt lds
    s_waitcnt lgkmcnt(6)
    v_mfma_f32_32x32x16_bf16 v[32:47], v[84:87], v[168:171], v[32:47]
    ds_read_b64_tr_b16 v[84:85], v10 offset:45056
    ds_read_b64_tr_b16 v[86:87], v10 offset:46080
    s_add_u32 s46, s40, 0x15000
    s_add_u32 m0, s45, 0x11000
    s_nop 0
    buffer_load_dwordx4 v1, s[12:15], s46 offen nt lds
    s_waitcnt lgkmcnt(6)
    v_mfma_f32_32x32x16_bf16 v[48:63], v[88:91], v[168:171], v[48:63]
    ds_read_b64_tr_b16 v[88:89], v11 offset:45056
    ds_read_b64_tr_b16 v[90:91], v11 offset:46080
    s_add_u32 s46, s40, 0x16000
    s_add_u32 m0, s45, 0x12000
    s_nop 0
    buffer_load_dwordx4 v1, s[12:15], s46 offen nt lds
    s_waitcnt lgkmcnt(6)
    v_mfma_f32_32x32x16_bf16 v[64:79], v[92:95], v[168:171], v[64:79]
    ds_read_b64_tr_b16 v[92:93], v12 offset:45056
    ds_read_b64_tr_b16 v[94:95], v12 offset:46080
    s_add_u32 s46, s40, 0x17000
    s_add_u32 m0, s45, 0x13000
    s_nop 0
    buffer_load_dwordx4 v1, s[12:15], s46 offen nt lds
    s_waitcnt lgkmcnt(6)
    v_mfma_f32_32x32x16_bf16 v[16:31], v[80:83], v[172:175], v[16:31]
    ds_read_b64_tr_b16 v[80:81], v9 offset:49152
    ds_read_b64_tr_b16 v[82:83], v9 offset:50176
    s_add_u32 s46, s40, 0x10000
    s_add_u32 m0, s45, 0x14000
    s_nop 0
    buffer_load_dwordx4 v2, s[16:19], s46 offen nt lds
    s_waitcnt lgkmcnt(6)
    v_mfma_f32_32x32x16_bf16 v[32:47], v[84:87], v[172:175], v[32:47]
    ds_read_b64_tr_b16 v[84:85], v10 offset:49152
    ds_read_b64_tr_b16 v[86:87], v10 offset:50176
    s_add_u32 s46, s40, 0x11000
    s_add_u32 m0, s45, 0x15000
    s_nop 0
    buffer_load_dwordx4 v2, s[16:19], s46 offen nt lds
    s_waitcnt lgkmcnt(6)
    v_mfma_f32_32x32x16_bf16 v[48:63], v[88:91], v[172:175], v[48:63]
    ds_read_b64_tr_b16 v[88:89], v11 offset:49152
    ds_read_b64_tr_b16 v[90:91], v11 offset:50176
    s_add_u32 s46, s40, 0x12000
    s_add_u32 m0, s45, 0x16000
    s_nop 0
    buffer_load_dwordx4 v2, s[16:19], s46 offen nt lds
    s_waitcnt lgkmcnt(6)
    v_mfma_f32_32x32x16_bf16 v[64:79], v[92:95], v[172:175], v[64:79]
    ds_read_b64_tr_b16 v[92:93], v12 offset:49152
    ds_read_b64_tr_b16 v[94:95], v12 offset:50176
    s_add_u32 s46, s40, 0x13000
    s_add_u32 m0, s45, 0x17000
    s_nop 0
    buffer_load_dwordx4 v2, s[16:19], s46 offen nt lds
    s_waitcnt lgkmcnt(6)
    v_mfma_f32_32x32x16_bf16 v[16:31], v[80:83], v[176:179], v[16:31]
    ds_read_b64_tr_b16 v[80:81], v9 offset:53248
    ds_read_b64_tr_b16 v[82:83], v9 offset:54272
    s_waitcnt lgkmcnt(6)
    v_mfma_f32_32x32x16_bf16 v[32:47], v[84:87], v[176:179], v[32:47]
    ds_read_b64_tr_b16 v[84:85], v10 offset:53248
    ds_read_b64_tr_b16 v[86:87], v10 offset:54272
    s_waitcnt lgkmcnt(6)
    v_mfma_f32_32x32x16_bf16 v[48:63], v[88:91], v[176:179], v[48:63]
    ds_read_b64_tr_b16 v[88:89], v11 offset:53248
    ds_read_b64_tr_b16 v[90:91], v11 offset:54272
    s_waitcnt lgkmcnt(6)
    v_mfma_f32_32x32x16_bf16 v[64:79], v[92:95], v[176:179], v[64:79]
    ds_read_b64_tr_b16 v[92:93], v12 offset:53248
    ds_read_b64_tr_b16 v[94:95], v12 offset:54272
    s_waitcnt lgkmcnt(6)
    v_mfma_f32_32x32x16_bf16 v[16:31], v[80:83], v[180:183], v[16:31]
    s_waitcnt lgkmcnt(4)
    v_mfma_f32_32x32x16_bf16 v[32:47], v[84:87], v[180:183], v[32:47]
    s_waitcnt lgkmcnt(2)
    v_mfma_f32_32x32x16_bf16 v[48:63], v[88:91], v[180:183], v[48:63]
    s_waitcnt lgkmcnt(0)
    v_mfma_f32_32x32x16_bf16 v[64:79], v[92:95], v[180:183], v[64:79]
    s_waitcnt vmcnt(8)
    s_barrier
    v_min_u32 v96, 39, v0
    v_lshlrev_b32 v96, 7, v96
    ds_read_b64_tr_b16 v[80:81], v9 offset:0
    ds_read_b64_tr_b16 v[82:83], v9 offset:1024
    ds_read_b64_tr_b16 v[84:85], v10 offset:0
    ds_read_b64_tr_b16 v[86:87], v10 offset:1024
    ds_read_b64_tr_b16 v[88:89], v11 offset:0
    ds_read_b64_tr_b16 v[90:91], v11 offset:1024
    ds_read_b64_tr_b16 v[92:93], v12 offset:0
    ds_read_b64_tr_b16 v[94:95], v12 offset:1024
    s_waitcnt lgkmcnt(6)
    v_mfma_f32_32x32x16_bf16 v[16:31], v[80:83], v[184:187], v[16:31]
    ds_read_b64_tr_b16 v[80:81], v9 offset:4096
    ds_read_b64_tr_b16 v[82:83], v9 offset:5120
    s_waitcnt lgkmcnt(6)
    v_mfma_f32_32x32x16_bf16 v[32:47], v[84:87], v[184:187], v[32:47]
    ds_read_b64_tr_b16 v[84:85], v10 offset:4096
    ds_read_b64_tr_b16 v[86:87], v10 offset:5120
    s_waitcnt lgkmcnt(6)
    v_mfma_f32_32x32x16_bf16 v[48:63], v[88:91], v[184:187], v[48:63]
    ds_read_b64_tr_b16 v[88:89], v11 offset:4096
    ds_read_b64_tr_b16 v[90:91], v11 offset:5120
    s_waitcnt lgkmcnt(6)
    v_mfma_f32_32x32x16_bf16 v[64:79], v[92:95], v[184:187], v[64:79]
    ds_read_b64_tr_b16 v[92:93], v12 offset:4096
    ds_read_b64_tr_b16 v[94:95], v12 offset:5120
    s_waitcnt lgkmcnt(6)
    v_mfma_f32_32x32x16_bf16 v[16:31], v[80:83], v[188:191], v[16:31]
    ds_read_b64_tr_b16 v[80:81], v9 offset:8192
    ds_read_b64_tr_b16 v[82:83], v9 offset:9216
    s_add_u32 m0, s45, 0x20000
    s_nop 0
    buffer_load_dwordx4 v3, s[20:23], s50 offen lds
    s_add_u32 s50, s50, 0x20000
    s_cmp_eq_u32 s50, 0x500000
    s_cselect_b32 s50, 0, s50
    s_add_u32 m0, s45, 0x21000
    s_nop 0
    buffer_load_dwordx4 v3, s[20:23], s50 offen lds
    s_add_u32 s50, s50, 0x20000
    s_cmp_eq_u32 s50, 0x500000
    s_cselect_b32 s50, 0, s50
    s_waitcnt lgkmcnt(6)
    v_mfma_f32_32x32x16_bf16 v[32:47], v[84:87], v[188:191], v[32:47]
    ds_read_b64_tr_b16 v[84:85], v10 offset:8192
    ds_read_b64_tr_b16 v[86:87], v10 offset:9216
    s_add_u32 m0, s45, 0x22000
    s_nop 0
    buffer_load_dwordx4 v3, s[20:23], s50 offen lds
    s_add_u32 s50, s50, 0x20000
    s_cmp_eq_u32 s50, 0x500000
    s_cselect_b32 s50, 0, s50
    s_waitcnt lgkmcnt(6)
    v_mfma_f32_32x32x16_bf16 v[48:63], v[88:91], v[188:191], v[48:63]
    ds_read_b64_tr_b16 v[88:89], v11 offset:8192
    ds_read_b64_tr_b16 v[90:91], v11 offset:9216
    s_add_u32 m0, s45, 0x23000
    s_nop 0
    buffer_load_dwordx4 v3, s[20:23], s50 offen lds
    s_add_u32 s50, s50, 0x20000
    s_cmp_eq_u32 s50, 0x500000
    s_cselect_b32 s50, 0, s50
    s_add_u32 m0, s45, 0x24000
    s_nop 0
    buffer_load_dwordx4 v3, s[20:23], s50 offen lds
    s_add_u32 s50, s50, 0x20000
    s_cmp_eq_u32 s50, 0x500000
    s_cselect_b32 s50, 0, s50
    s_waitcnt lgkmcnt(6)
    v_mfma_f32_32x32x16_bf16 v[64:79], v[92:95], v[188:191], v[64:79]
    ds_read_b64_tr_b16 v[92:93], v12 offset:8192
    ds_read_b64_tr_b16 v[94:95], v12 offset:9216
    s_lshr_b32 s47, s2, 3
    s_mul_i32 s47, s47, 20480
    s_add_u32 s47, s47, s59
    s_add_u32 s47, s47, s63
    s_add_u32 s47, s47, 0x0
    buffer_load_dword v97, v96, s[24:27], s47 offen
    s_waitcnt lgkmcnt(6)
    v_mfma_f32_32x32x16_bf16 v[16:31], v[80:83], v[192:195], v[16:31]
    ds_read_b64_tr_b16 v[80:81], v9 offset:12288
    ds_read_b64_tr_b16 v[82:83], v9 offset:13312
    s_add_u32 s46, s40, 0x18000
    s_add_u32 m0, s45, 0x0
    s_nop 0
    buffer_load_dwordx4 v1, s[12:15], s46 offen nt lds
    s_waitcnt lgkmcnt(6)
    v_mfma_f32_32x32x16_bf16 v[32:47], v[84:87], v[192:195], v[32:47]
    ds_read_b64_tr_b16 v[84:85], v10 offset:12288
    ds_read_b64_tr_b16 v[86:87], v10 offset:13312
    s_add_u32 s46, s40, 0x19000
    s_add_u32 m0, s45, 0x1000
    s_nop 0
    buffer_load_dwordx4 v1, s[12:15], s46 offen nt lds
    s_add_u32 s46, s40, 0x1a000
    s_add_u32 m0, s45, 0x2000
    s_nop 0
    buffer_load_dwordx4 v1, s[12:15], s46 offen nt lds
    s_waitcnt lgkmcnt(6)
    v_mfma_f32_32x32x16_bf16 v[48:63], v[88:91], v[192:195], v[48:63]
    ds_read_b64_tr_b16 v[88:89], v11 offset:12288
    ds_read_b64_tr_b16 v[90:91], v11 offset:13312
    s_add_u32 s46, s40, 0x1b000
    s_add_u32 m0, s45, 0x3000
    s_nop 0
    buffer_load_dwordx4 v1, s[12:15], s46 offen nt lds
    s_waitcnt lgkmcnt(6)
    v_mfma_f32_32x32x16_bf16 v[64:79], v[92:95], v[192:195], v[64:79]
    ds_read_b64_tr_b16 v[92:93], v12 offset:12288
    ds_read_b64_tr_b16 v[94:95], v12 offset:13312
    s_add_u32 s46, s40, 0x14000
    s_add_u32 m0, s45, 0x4000
    s_nop 0
    buffer_load_dwordx4 v2, s[16:19], s46 offen nt lds
    s_add_u32 s46, s40, 0x15000
    s_add_u32 m0, s45, 0x5000
    s_nop 0
    buffer_load_dwordx4 v2, s[16:19], s46 offen nt lds
    s_waitcnt lgkmcnt(6)
    v_mfma_f32_32x32x16_bf16 v[16:31], v[80:83], v[196:199], v[16:31]
    ds_read_b64_tr_b16 v[80:81], v9 offset:16384
    ds_read_b64_tr_b16 v[82:83], v9 offset:17408
    s_add_u32 s46, s40, 0x16000
    s_add_u32 m0, s45, 0x6000
    s_nop 0
    buffer_load_dwordx4 v2, s[16:19], s46 offen nt lds
    s_waitcnt lgkmcnt(6)
    v_mfma_f32_32x32x16_bf16 v[32:47], v[84:87], v[196:199], v[32:47]
    ds_read_b64_tr_b16 v[84:85], v10 offset:16384
    ds_read_b64_tr_b16 v[86:87], v10 offset:17408
    s_add_u32 s46, s40, 0x17000
    s_add_u32 m0, s45, 0x7000
    s_nop 0
    buffer_load_dwordx4 v2, s[16:19], s46 offen nt lds
    s_waitcnt lgkmcnt(6)
    v_mfma_f32_32x32x16_bf16 v[48:63], v[88:91], v[196:199], v[48:63]
    ds_read_b64_tr_b16 v[88:89], v11 offset:16384
    ds_read_b64_tr_b16 v[90:91], v11 offset:17408
    s_waitcnt lgkmcnt(6)
    v_mfma_f32_32x32x16_bf16 v[64:79], v[92:95], v[196:199], v[64:79]
    ds_read_b64_tr_b16 v[92:93], v12 offset:16384
    ds_read_b64_tr_b16 v[94:95], v12 offset:17408
    s_waitcnt lgkmcnt(6)
    v_mfma_f32_32x32x16_bf16 v[16:31], v[80:83], v[200:203], v[16:31]
    s_waitcnt lgkmcnt(4)
    v_mfma_f32_32x32x16_bf16 v[32:47], v[84:87], v[200:203], v[32:47]
    s_waitcnt lgkmcnt(2)
    v_mfma_f32_32x32x16_bf16 v[48:63], v[88:91], v[200:203], v[48:63]
    s_waitcnt lgkmcnt(0)
    v_mfma_f32_32x32x16_bf16 v[64:79], v[92:95], v[200:203], v[64:79]
    s_waitcnt vmcnt(9)
    s_barrier
    ds_read_b64_tr_b16 v[80:81], v9 offset:32768
    ds_read_b64_tr_b16 v[82:83], v9 offset:33792
    ds_read_b64_tr_b16 v[84:85], v10 offset:32768
    ds_read_b64_tr_b16 v[86:87], v10 offset:33792
    ds_read_b64_tr_b16 v[88:89], v11 offset:32768
    ds_read_b64_tr_b16 v[90:91], v11 offset:33792
    ds_read_b64_tr_b16 v[92:93], v12 offset:32768
    ds_read_b64_tr_b16 v[94:95], v12 offset:33792
    s_waitcnt lgkmcnt(6)
    v_mfma_f32_32x32x16_bf16 v[16:31], v[80:83], v[204:207], v[16:31]
    ds_read_b64_tr_b16 v[80:81], v9 offset:36864
    ds_read_b64_tr_b16 v[82:83], v9 offset:37888
    s_waitcnt lgkmcnt(6)
    v_mfma_f32_32x32x16_bf16 v[32:47], v[84:87], v[204:207], v[32:47]
    ds_read_b64_tr_b16 v[84:85], v10 offset:36864
    ds_read_b64_tr_b16 v[86:87], v10 offset:37888
    s_waitcnt lgkmcnt(6)
    v_mfma_f32_32x32x16_bf16 v[48:63], v[88:91], v[204:207], v[48:63]
    ds_read_b64_tr_b16 v[88:89], v11 offset:36864
    ds_read_b64_tr_b16 v[90:91], v11 offset:37888
    s_waitcnt lgkmcnt(6)
    v_mfma_f32_32x32x16_bf16 v[64:79], v[92:95], v[204:207], v[64:79]
    ds_read_b64_tr_b16 v[92:93], v12 offset:36864
    ds_read_b64_tr_b16 v[94:95], v12 offset:37888
    s_waitcnt lgkmcnt(6)
    v_mfma_f32_32x32x16_bf16 v[16:31], v[80:83], v[208:211], v[16:31]
    ds_read_b64_tr_b16 v[80:81], v9 offset:40960
    ds_read_b64_tr_b16 v[82:83], v9 offset:41984
    s_add_u32 m0, s45, 0x18000
    s_nop 0
    buffer_load_dwordx4 v3, s[20:23], s50 offen lds
    s_add_u32 s50, s50, 0x20000
    s_cmp_eq_u32 s50, 0x500000
    s_cselect_b32 s50, 0, s50
    s_add_u32 m0, s45, 0x19000
    s_nop 0
    buffer_load_dwordx4 v3, s[20:23], s50 offen lds
    s_add_u32 s50, s50, 0x20000
    s_cmp_eq_u32 s50, 0x500000
    s_cselect_b32 s50, 0, s50
    s_waitcnt lgkmcnt(6)
    v_mfma_f32_32x32x16_bf16 v[32:47], v[84:87], v[208:211], v[32:47]
    ds_read_b64_tr_b16 v[84:85], v10 offset:40960
    ds_read_b64_tr_b16 v[86:87], v10 offset:41984
    s_add_u32 m0, s45, 0x1a000
    s_nop 0
    buffer_load_dwordx4 v3, s[20:23], s50 offen lds
    s_add_u32 s50, s50, 0x20000
    s_cmp_eq_u32 s50, 0x500000
    s_cselect_b32 s50, 0, s50
    s_waitcnt lgkmcnt(6)
    v_mfma_f32_32x32x16_bf16 v[48:63], v[88:91], v[208:211], v[48:63]
    ds_read_b64_tr_b16 v[88:89], v11 offset:40960
    ds_read_b64_tr_b16 v[90:91], v11 offset:41984
    s_add_u32 m0, s45, 0x1b000
    s_nop 0
    buffer_load_dwordx4 v3, s[20:23], s50 offen lds
    s_add_u32 s50, s50, 0x20000
    s_cmp_eq_u32 s50, 0x500000
    s_cselect_b32 s50, 0, s50
    s_waitcnt lgkmcnt(6)
    v_mfma_f32_32x32x16_bf16 v[64:79], v[92:95], v[208:211], v[64:79]
    ds_read_b64_tr_b16 v[92:93], v12 offset:40960
    ds_read_b64_tr_b16 v[94:95], v12 offset:41984
    s_add_u32 m0, s45, 0x1c000
    s_nop 0
    buffer_load_dwordx4 v3, s[20:23], s50 offen lds
    s_add_u32 s50, s50, 0x20000
    s_cmp_eq_u32 s50, 0x500000
    s_cselect_b32 s50, 0, s50
    s_add_u32 s46, s40, 0x1c000
    s_add_u32 m0, s45, 0x8000
    s_nop 0
    buffer_load_dwordx4 v1, s[12:15], s46 offen nt lds
    s_waitcnt lgkmcnt(6)
    v_mfma_f32_32x32x16_bf16 v[16:31], v[80:83], v[212:215], v[16:31]
    ds_read_b64_tr_b16 v[80:81], v9 offset:45056
    ds_read_b64_tr_b16 v[82:83], v9 offset:46080
    s_add_u32 s46, s40, 0x1d000
    s_add_u32 m0, s45, 0x9000
    s_nop 0
    buffer_load_dwordx4 v1, s[12:15], s46 offen nt lds
    s_waitcnt lgkmcnt(6)
    v_mfma_f32_32x32x16_bf16 v[32:47], v[84:87], v[212:215], v[32:47]
    ds_read_b64_tr_b16 v[84:85], v10 offset:45056
    ds_read_b64_tr_b16 v[86:87], v10 offset:46080
    s_add_u32 s46, s40, 0x1e000
    s_add_u32 m0, s45, 0xa000
    s_nop 0
    buffer_load_dwordx4 v1, s[12:15], s46 offen nt lds
    s_waitcnt lgkmcnt(6)
    v_mfma_f32_32x32x16_bf16 v[48:63], v[88:91], v[212:215], v[48:63]
    ds_read_b64_tr_b16 v[88:89], v11 offset:45056
    ds_read_b64_tr_b16 v[90:91], v11 offset:46080
    s_add_u32 s46, s40, 0x1f000
    s_add_u32 m0, s45, 0xb000
    s_nop 0
    buffer_load_dwordx4 v1, s[12:15], s46 offen nt lds
    s_add_u32 s46, s40, 0x18000
    s_add_u32 m0, s45, 0xc000
    s_nop 0
    buffer_load_dwordx4 v2, s[16:19], s46 offen nt lds
    s_waitcnt lgkmcnt(6)
    v_mfma_f32_32x32x16_bf16 v[64:79], v[92:95], v[212:215], v[64:79]
    ds_read_b64_tr_b16 v[92:93], v12 offset:45056
    ds_read_b64_tr_b16 v[94:95], v12 offset:46080
    s_add_u32 s46, s40, 0x19000
    s_add_u32 m0, s45, 0xd000
    s_nop 0
    buffer_load_dwordx4 v2, s[16:19], s46 offen nt lds
    s_waitcnt lgkmcnt(6)
    v_mfma_f32_32x32x16_bf16 v[16:31], v[80:83], v[216:219], v[16:31]
    ds_read_b64_tr_b16 v[80:81], v9 offset:49152
    ds_read_b64_tr_b16 v[82:83], v9 offset:50176
    s_add_u32 s46, s40, 0x1a000
    s_add_u32 m0, s45, 0xe000
    s_nop 0
    buffer_load_dwordx4 v2, s[16:19], s46 offen nt lds
    s_waitcnt lgkmcnt(6)
    v_mfma_f32_32x32x16_bf16 v[32:47], v[84:87], v[216:219], v[32:47]
    ds_read_b64_tr_b16 v[84:85], v10 offset:49152
    ds_read_b64_tr_b16 v[86:87], v10 offset:50176
    s_add_u32 s46, s40, 0x1b000
    s_add_u32 m0, s45, 0xf000
    s_nop 0
    buffer_load_dwordx4 v2, s[16:19], s46 offen nt lds
    s_waitcnt lgkmcnt(6)
    v_mfma_f32_32x32x16_bf16 v[48:63], v[88:91], v[216:219], v[48:63]
    ds_read_b64_tr_b16 v[88:89], v11 offset:49152
    ds_read_b64_tr_b16 v[90:91], v11 offset:50176
    s_waitcnt lgkmcnt(6)
    v_mfma_f32_32x32x16_bf16 v[64:79], v[92:95], v[216:219], v[64:79]
    ds_read_b64_tr_b16 v[92:93], v12 offset:49152
    ds_read_b64_tr_b16 v[94:95], v12 offset:50176
    s_waitcnt lgkmcnt(6)
    v_mfma_f32_32x32x16_bf16 v[16:31], v[80:83], v[220:223], v[16:31]
    s_waitcnt lgkmcnt(4)
    v_mfma_f32_32x32x16_bf16 v[32:47], v[84:87], v[220:223], v[32:47]
    s_waitcnt lgkmcnt(2)
    v_mfma_f32_32x32x16_bf16 v[48:63], v[88:91], v[220:223], v[48:63]
    s_waitcnt lgkmcnt(0)
    v_mfma_f32_32x32x16_bf16 v[64:79], v[92:95], v[220:223], v[64:79]
    s_waitcnt vmcnt(8)
    s_barrier
    s_mul_i32 s46, s4, 20480
    s_mul_i32 s47, s41, 320
    s_add_u32 s46, s46, s47
    s_movk_i32 s47, 3277
    s_movk_i32 s48, 960
    v_add_u32 v14, 0, v0
    v_mul_lo_u32 v15, v14, s47
    v_lshrrev_b32 v15, 16, v15
    v_mul_lo_u32 v15, v15, s48
    v_lshl_add_u32 v15, v14, 4, v15
    v_add_u32 v144, s46, v15
    v_add_u32 v14, 64, v0
    v_mul_lo_u32 v15, v14, s47
    v_lshrrev_b32 v15, 16, v15
    v_mul_lo_u32 v15, v15, s48
    v_lshl_add_u32 v15, v14, 4, v15
    v_add_u32 v145, s46, v15
    v_add_u32 v14, 128, v0
    v_mul_lo_u32 v15, v14, s47
    v_lshrrev_b32 v15, 16, v15
    v_mul_lo_u32 v15, v15, s48
    v_lshl_add_u32 v15, v14, 4, v15
    v_add_u32 v146, s46, v15
    v_add_u32 v14, 192, v0
    v_mul_lo_u32 v15, v14, s47
    v_lshrrev_b32 v15, 16, v15
    v_mul_lo_u32 v15, v15, s48
    v_lshl_add_u32 v15, v14, 4, v15
    v_add_u32 v147, s46, v15
    v_add_u32 v14, 256, v0
    v_mul_lo_u32 v15, v14, s47
    v_lshrrev_b32 v15, 16, v15
    v_mul_lo_u32 v15, v15, s48
    v_lshl_add_u32 v15, v14, 4, v15
    v_add_u32 v148, s46, v15
    ds_read_b64_tr_b16 v[80:81], v9 offset:0
    ds_read_b64_tr_b16 v[82:83], v9 offset:1024
    ds_read_b64_tr_b16 v[84:85], v10 offset:0
    ds_read_b64_tr_b16 v[86:87], v10 offset:1024
    ds_read_b64_tr_b16 v[88:89], v11 offset:0
    ds_read_b64_tr_b16 v[90:91], v11 offset:1024
    ds_read_b64_tr_b16 v[92:93], v12 offset:0
    ds_read_b64_tr_b16 v[94:95], v12 offset:1024
    s_waitcnt lgkmcnt(6)
    v_mfma_f32_32x32x16_bf16 v[16:31], v[80:83], v[224:227], v[16:31]
    ds_read_b64_tr_b16 v[80:81], v9 offset:4096
    ds_read_b64_tr_b16 v[82:83], v9 offset:5120
    s_waitcnt lgkmcnt(6)
    v_mfma_f32_32x32x16_bf16 v[32:47], v[84:87], v[224:227], v[32:47]
    ds_read_b64_tr_b16 v[84:85], v10 offset:4096
    ds_read_b64_tr_b16 v[86:87], v10 offset:5120
    s_waitcnt lgkmcnt(6)
    v_mfma_f32_32x32x16_bf16 v[48:63], v[88:91], v[224:227], v[48:63]
    ds_read_b64_tr_b16 v[88:89], v11 offset:4096
    ds_read_b64_tr_b16 v[90:91], v11 offset:5120
    s_waitcnt lgkmcnt(6)
    v_mfma_f32_32x32x16_bf16 v[64:79], v[92:95], v[224:227], v[64:79]
    ds_read_b64_tr_b16 v[92:93], v12 offset:4096
    ds_read_b64_tr_b16 v[94:95], v12 offset:5120
    s_waitcnt lgkmcnt(6)
    v_mfma_f32_32x32x16_bf16 v[16:31], v[80:83], v[228:231], v[16:31]
    ds_read_b64_tr_b16 v[80:81], v9 offset:8192
    ds_read_b64_tr_b16 v[82:83], v9 offset:9216
    s_add_u32 m0, s45, 0x20000
    s_nop 0
    buffer_load_dwordx4 v3, s[20:23], s50 offen lds
    s_add_u32 s50, s50, 0x20000
    s_cmp_eq_u32 s50, 0x500000
    s_cselect_b32 s50, 0, s50
    s_add_u32 m0, s45, 0x21000
    s_nop 0
    buffer_load_dwordx4 v3, s[20:23], s50 offen lds
    s_add_u32 s50, s50, 0x20000
    s_cmp_eq_u32 s50, 0x500000
    s_cselect_b32 s50, 0, s50
    s_waitcnt lgkmcnt(6)
    v_mfma_f32_32x32x16_bf16 v[32:47], v[84:87], v[228:231], v[32:47]
    ds_read_b64_tr_b16 v[84:85], v10 offset:8192
    ds_read_b64_tr_b16 v[86:87], v10 offset:9216
    s_add_u32 m0, s45, 0x22000
    s_nop 0
    buffer_load_dwordx4 v3, s[20:23], s50 offen lds
    s_add_u32 s50, s50, 0x20000
    s_cmp_eq_u32 s50, 0x500000
    s_cselect_b32 s50, 0, s50
    s_waitcnt lgkmcnt(6)
    v_mfma_f32_32x32x16_bf16 v[48:63], v[88:91], v[228:231], v[48:63]
    ds_read_b64_tr_b16 v[88:89], v11 offset:8192
    ds_read_b64_tr_b16 v[90:91], v11 offset:9216
    s_add_u32 s46, s40, 0x200000
    s_add_u32 m0, s45, 0x10000
    s_nop 0
    buffer_load_dwordx4 v1, s[12:15], s46 offen nt lds
    s_waitcnt lgkmcnt(6)
    v_mfma_f32_32x32x16_bf16 v[64:79], v[92:95], v[228:231], v[64:79]
    ds_read_b64_tr_b16 v[92:93], v12 offset:8192
    ds_read_b64_tr_b16 v[94:95], v12 offset:9216
    s_add_u32 s46, s40, 0x201000
    s_add_u32 m0, s45, 0x11000
    s_nop 0
    buffer_load_dwordx4 v1, s[12:15], s46 offen nt lds
    s_waitcnt lgkmcnt(6)
    v_mfma_f32_32x32x16_bf16 v[16:31], v[80:83], v[232:235], v[16:31]
    ds_read_b64_tr_b16 v[80:81], v9 offset:12288
    ds_read_b64_tr_b16 v[82:83], v9 offset:13312
    s_add_u32 s46, s40, 0x202000
    s_add_u32 m0, s45, 0x12000
    s_nop 0
    buffer_load_dwordx4 v1, s[12:15], s46 offen nt lds
    s_waitcnt lgkmcnt(6)
    v_mfma_f32_32x32x16_bf16 v[32:47], v[84:87], v[232:235], v[32:47]
    ds_read_b64_tr_b16 v[84:85], v10 offset:12288
    ds_read_b64_tr_b16 v[86:87], v10 offset:13312
    s_add_u32 s46, s40, 0x203000
    s_add_u32 m0, s45, 0x13000
    s_nop 0
    buffer_load_dwordx4 v1, s[12:15], s46 offen nt lds
    s_waitcnt lgkmcnt(6)
    v_mfma_f32_32x32x16_bf16 v[48:63], v[88:91], v[232:235], v[48:63]
    ds_read_b64_tr_b16 v[88:89], v11 offset:12288
    ds_read_b64_tr_b16 v[90:91], v11 offset:13312
    s_add_u32 s46, s40, 0x1c000
    s_add_u32 m0, s45, 0x14000
    s_nop 0
    buffer_load_dwordx4 v2, s[16:19], s46 offen nt lds
    s_waitcnt lgkmcnt(6)
    v_mfma_f32_32x32x16_bf16 v[64:79], v[92:95], v[232:235], v[64:79]
    ds_read_b64_tr_b16 v[92:93], v12 offset:12288
    ds_read_b64_tr_b16 v[94:95], v12 offset:13312
    s_add_u32 s46, s40, 0x1d000
    s_add_u32 m0, s45, 0x15000
    s_nop 0
    buffer_load_dwordx4 v2, s[16:19], s46 offen nt lds
    s_waitcnt lgkmcnt(6)
    v_mfma_f32_32x32x16_bf16 v[16:31], v[80:83], v[236:239], v[16:31]
    ds_read_b64_tr_b16 v[80:81], v9 offset:16384
    ds_read_b64_tr_b16 v[82:83], v9 offset:17408
    s_add_u32 s46, s40, 0x1e000
    s_add_u32 m0, s45, 0x16000
    s_nop 0
    buffer_load_dwordx4 v2, s[16:19], s46 offen nt lds
    s_waitcnt lgkmcnt(6)
    v_mfma_f32_32x32x16_bf16 v[32:47], v[84:87], v[236:239], v[32:47]
    ds_read_b64_tr_b16 v[84:85], v10 offset:16384
    ds_read_b64_tr_b16 v[86:87], v10 offset:17408
    s_add_u32 s46, s40, 0x1f000
    s_add_u32 m0, s45, 0x17000
    s_nop 0
    buffer_load_dwordx4 v2, s[16:19], s46 offen nt lds
    s_waitcnt lgkmcnt(6)
    v_mfma_f32_32x32x16_bf16 v[48:63], v[88:91], v[236:239], v[48:63]
    ds_read_b64_tr_b16 v[88:89], v11 offset:16384
    ds_read_b64_tr_b16 v[90:91], v11 offset:17408
    s_waitcnt lgkmcnt(6)
    v_mfma_f32_32x32x16_bf16 v[64:79], v[92:95], v[236:239], v[64:79]
    ds_read_b64_tr_b16 v[92:93], v12 offset:16384
    ds_read_b64_tr_b16 v[94:95], v12 offset:17408
    s_waitcnt lgkmcnt(6)
    v_mfma_f32_32x32x16_bf16 v[16:31], v[80:83], v[240:243], v[16:31]
    s_waitcnt lgkmcnt(4)
    v_mfma_f32_32x32x16_bf16 v[32:47], v[84:87], v[240:243], v[32:47]
    s_waitcnt lgkmcnt(2)
    v_mfma_f32_32x32x16_bf16 v[48:63], v[88:91], v[240:243], v[48:63]
    s_waitcnt lgkmcnt(0)
    v_mfma_f32_32x32x16_bf16 v[64:79], v[92:95], v[240:243], v[64:79]
    s_waitcnt vmcnt(8)
    s_barrier
    v_and_b32 v14, 19, v0
    v_bfe_u32 v15, v0, 2, 1
    v_lshl_add_u32 v14, v15, 3, v14
    v_bfe_u32 v15, v0, 3, 1
    v_lshl_add_u32 v14, v15, 2, v14
    v_lshrrev_b32 v15, 5, v0
    v_xor_b32 v15, v15, v14
    v_and_b32 v15, 15, v15
    v_lshlrev_b32 v15, 4, v15
    v_lshl_add_u32 v14, v14, 8, v15
    v_add_u32 v14, 0x10000, v14
    v_xor_b32 v224, 0x0, v14
    v_xor_b32 v225, 0x20, v14
    v_xor_b32 v226, 0x40, v14
    v_xor_b32 v227, 0x60, v14
    v_xor_b32 v228, 0x80, v14
    v_xor_b32 v229, 0xa0, v14
    v_xor_b32 v230, 0xc0, v14
    v_xor_b32 v231, 0xe0, v14
    v_add_u32 v232, 0x14000, v5
    v_add_u32 v233, 0x14000, v6
    v_add_u32 v234, 0x14000, v7
    v_add_u32 v235, 0x14000, v8
    s_mov_b32 s54, 2
    ds_read_b64_tr_b16 v[112:113], v9 offset:32768
    ds_read_b64_tr_b16 v[114:115], v9 offset:33792
    ds_read_b64_tr_b16 v[116:117], v9 offset:36864
    ds_read_b64_tr_b16 v[118:119], v9 offset:37888
    ds_read_b64_tr_b16 v[120:121], v9 offset:40960
    ds_read_b64_tr_b16 v[122:123], v9 offset:41984
    ds_read_b64_tr_b16 v[124:125], v10 offset:32768
    ds_read_b64_tr_b16 v[126:127], v10 offset:33792
    s_waitcnt lgkmcnt(6)
    v_mfma_f32_32x32x16_bf16 v[16:31], v[112:115], v[244:247], v[16:31]
    ds_read_b64_tr_b16 v[112:113], v10 offset:36864
    ds_read_b64_tr_b16 v[114:115], v10 offset:37888
    s_waitcnt lgkmcnt(6)
    v_mfma_f32_32x32x16_bf16 v[16:31], v[116:119], v[248:251], v[16:31]
    ds_read_b64_tr_b16 v[116:117], v10 offset:40960
    ds_read_b64_tr_b16 v[118:119], v10 offset:41984
    s_waitcnt lgkmcnt(6)
    v_mfma_f32_32x32x16_bf16 v[16:31], v[120:123], v[252:255], v[16:31]
    ds_read_b64_tr_b16 v[120:121], v11 offset:32768
    ds_read_b64_tr_b16 v[122:123], v11 offset:33792
    s_waitcnt lgkmcnt(6)
    v_mfma_f32_32x32x16_bf16 v[32:47], v[124:127], v[244:247], v[32:47]
    ds_read_b64_tr_b16 v[124:125], v11 offset:36864
    ds_read_b64_tr_b16 v[126:127], v11 offset:37888
    s_waitcnt lgkmcnt(6)
    v_mfma_f32_32x32x16_bf16 v[32:47], v[112:115], v[248:251], v[32:47]
    ds_read_b64_tr_b16 v[112:113], v11 offset:40960
    ds_read_b64_tr_b16 v[114:115], v11 offset:41984
    s_nop 1
    v_mul_f32 v16, s44, v16
    v_mul_f32 v17, s44, v17
    v_mul_f32 v18, s44, v18
    v_mul_f32 v19, s44, v19
    v_cvt_pk_bf16_f32 v80, v16, v17
    v_mul_f32 v20, s44, v20
    v_mul_f32 v21, s44, v21
    v_cvt_pk_bf16_f32 v81, v18, v19
    v_mul_f32 v22, s44, v22
    v_mul_f32 v23, s44, v23
    v_cvt_pk_bf16_f32 v82, v20, v21
    v_mul_f32 v24, s44, v24
    s_lshl1_add_u32 s47, s41, 0
    s_and_b32 s47, s47, 7
    s_mul_i32 s47, s47, 81920
    s_add_u32 s47, s47, s59
    s_add_u32 s49, s63, 0x19000
    s_add_u32 m0, s49, 0
    s_nop 0
    buffer_load_dwordx4 v144, s[24:27], s47 offen lds
    s_add_u32 m0, s49, 1024
    s_nop 0
    buffer_load_dwordx4 v145, s[24:27], s47 offen lds
    s_add_u32 m0, s49, 2048
    s_nop 0
    buffer_load_dwordx4 v146, s[24:27], s47 offen lds
    s_add_u32 m0, s49, 3072
    s_nop 0
    buffer_load_dwordx4 v147, s[24:27], s47 offen lds
    s_waitcnt lgkmcnt(6)
    v_mfma_f32_32x32x16_bf16 v[32:47], v[116:119], v[252:255], v[32:47]
    ds_read_b64_tr_b16 v[116:117], v12 offset:32768
    ds_read_b64_tr_b16 v[118:119], v12 offset:33792
    v_mul_f32 v25, s44, v25
    v_cvt_pk_bf16_f32 v83, v22, v23
    v_mul_f32 v26, s44, v26
    v_mul_f32 v27, s44, v27
    v_cvt_pk_bf16_f32 v84, v24, v25
    v_mul_f32 v28, s44, v28
    v_mul_f32 v29, s44, v29
    v_cvt_pk_bf16_f32 v85, v26, v27
    v_mul_f32 v30, s44, v30
    v_mul_f32 v31, s44, v31
    v_cvt_pk_bf16_f32 v86, v28, v29
    v_cvt_pk_bf16_f32 v87, v30, v31
    s_add_u32 m0, s49, 4096
    s_nop 0
    buffer_load_dwordx4 v148, s[24:27], s47 offen lds
    s_add_u32 s46, s40, 0x204000
    s_add_u32 m0, s45, 0x0
    s_nop 0
    buffer_load_dwordx4 v1, s[12:15], s46 offen nt lds
    s_add_u32 s46, s40, 0x205000
    s_add_u32 m0, s45, 0x1000
    s_nop 0
    buffer_load_dwordx4 v1, s[12:15], s46 offen nt lds
    s_waitcnt lgkmcnt(6)
    v_mfma_f32_32x32x16_bf16 v[48:63], v[120:123], v[244:247], v[48:63]
    ds_read_b64_tr_b16 v[120:121], v12 offset:36864
    ds_read_b64_tr_b16 v[122:123], v12 offset:37888
    s_add_u32 s46, s40, 0x206000
    s_add_u32 m0, s45, 0x2000
    s_nop 0
    buffer_load_dwordx4 v1, s[12:15], s46 offen nt lds
    s_add_u32 s46, s40, 0x207000
    s_add_u32 m0, s45, 0x3000
    s_nop 0
    buffer_load_dwordx4 v1, s[12:15], s46 offen nt lds
    s_add_u32 s46, s40, 0x200000
    s_add_u32 m0, s45, 0x4000
    s_nop 0
    buffer_load_dwordx4 v2, s[16:19], s46 offen nt lds
    s_waitcnt lgkmcnt(6)
    v_mfma_f32_32x32x16_bf16 v[48:63], v[124:127], v[248:251], v[48:63]
    ds_read_b64_tr_b16 v[124:125], v12 offset:40960
    ds_read_b64_tr_b16 v[126:127], v12 offset:41984
    v_mul_f32 v32, s44, v32
    v_mul_f32 v33, s44, v33
    v_mul_f32 v34, s44, v34
    v_mul_f32 v35, s44, v35
    v_cvt_pk_bf16_f32 v88, v32, v33
    v_mul_f32 v36, s44, v36
    v_mul_f32 v37, s44, v37
    v_cvt_pk_bf16_f32 v89, v34, v35
    v_mul_f32 v38, s44, v38
    v_mul_f32 v39, s44, v39
    v_cvt_pk_bf16_f32 v90, v36, v37
    v_mul_f32 v40, s44, v40
    s_add_u32 s46, s40, 0x201000
    s_add_u32 m0, s45, 0x5000
    s_nop 0
    buffer_load_dwordx4 v2, s[16:19], s46 offen nt lds
    s_add_u32 s46, s40, 0x202000
    s_add_u32 m0, s45, 0x6000
    s_nop 0
    buffer_load_dwordx4 v2, s[16:19], s46 offen nt lds
    s_add_u32 s46, s40, 0x203000
    s_add_u32 m0, s45, 0x7000
    s_nop 0
    buffer_load_dwordx4 v2, s[16:19], s46 offen nt lds
    s_waitcnt lgkmcnt(6)
    v_mfma_f32_32x32x16_bf16 v[48:63], v[112:115], v[252:255], v[48:63]
    v_mul_f32 v41, s44, v41
    v_cvt_pk_bf16_f32 v91, v38, v39
    v_mul_f32 v42, s44, v42
    v_mul_f32 v43, s44, v43
    v_cvt_pk_bf16_f32 v92, v40, v41
    v_mul_f32 v44, s44, v44
    v_mul_f32 v45, s44, v45
    v_cvt_pk_bf16_f32 v93, v42, v43
    v_mul_f32 v46, s44, v46
    v_mul_f32 v47, s44, v47
    v_cvt_pk_bf16_f32 v94, v44, v45
    v_cvt_pk_bf16_f32 v95, v46, v47
    s_waitcnt lgkmcnt(4)
    v_mfma_f32_32x32x16_bf16 v[64:79], v[116:119], v[244:247], v[64:79]
    s_waitcnt lgkmcnt(2)
    v_mfma_f32_32x32x16_bf16 v[64:79], v[120:123], v[248:251], v[64:79]
    v_mul_f32 v48, s44, v48
    v_mul_f32 v49, s44, v49
    v_mul_f32 v50, s44, v50
    v_mul_f32 v51, s44, v51
    v_cvt_pk_bf16_f32 v96, v48, v49
    v_mul_f32 v52, s44, v52
    v_mul_f32 v53, s44, v53
    v_cvt_pk_bf16_f32 v97, v50, v51
    v_mul_f32 v54, s44, v54
    v_mul_f32 v55, s44, v55
    v_cvt_pk_bf16_f32 v98, v52, v53
    v_mul_f32 v56, s44, v56
    s_waitcnt lgkmcnt(0)
    v_mfma_f32_32x32x16_bf16 v[64:79], v[124:127], v[252:255], v[64:79]
    v_mul_f32 v57, s44, v57
    v_cvt_pk_bf16_f32 v99, v54, v55
    v_mul_f32 v58, s44, v58
    v_mul_f32 v59, s44, v59
    v_cvt_pk_bf16_f32 v100, v56, v57
    v_mul_f32 v60, s44, v60
    v_mul_f32 v61, s44, v61
    v_cvt_pk_bf16_f32 v101, v58, v59
    v_mul_f32 v62, s44, v62
    v_mul_f32 v63, s44, v63
    v_cvt_pk_bf16_f32 v102, v60, v61
    v_cvt_pk_bf16_f32 v103, v62, v63
    v_mul_f32 v64, s44, v64
    v_mul_f32 v65, s44, v65
    v_mul_f32 v66, s44, v66
    v_mul_f32 v67, s44, v67
    v_cvt_pk_bf16_f32 v104, v64, v65
    v_mul_f32 v68, s44, v68
    v_mul_f32 v69, s44, v69
    v_cvt_pk_bf16_f32 v105, v66, v67
    v_mul_f32 v70, s44, v70
    v_mul_f32 v71, s44, v71
    v_cvt_pk_bf16_f32 v106, v68, v69
    v_mul_f32 v72, s44, v72
    v_mul_f32 v73, s44, v73
    v_cvt_pk_bf16_f32 v107, v70, v71
    v_mul_f32 v74, s44, v74
    v_mul_f32 v75, s44, v75
    v_cvt_pk_bf16_f32 v108, v72, v73
    v_mul_f32 v76, s44, v76
    v_mul_f32 v77, s44, v77
    v_cvt_pk_bf16_f32 v109, v74, v75
    v_mul_f32 v78, s44, v78
    v_mul_f32 v79, s44, v79
    v_cvt_pk_bf16_f32 v110, v76, v77
    v_cvt_pk_bf16_f32 v111, v78, v79
    s_waitcnt vmcnt(13)
    s_barrier
    s_setprio 0
    ds_read_b128 v[176:179], v224 offset:0
    ds_read_b128 v[180:183], v224 offset:8192
    ds_read_b128 v[184:187], v225 offset:0
    ds_read_b128 v[188:191], v225 offset:8192
    ds_read_b128 v[192:195], v226 offset:0
    ds_read_b128 v[196:199], v226 offset:8192
    ds_read_b128 v[200:203], v227 offset:0
    ds_read_b128 v[204:207], v227 offset:8192
    s_add_u32 s54, s54, 1
    s_cmp_eq_u32 s54, 3
    s_cselect_b32 s54, 0, s54
    s_mov_b32 s53, 0x8000
    s_cselect_b32 s53, 0xffff0000, s53
    s_waitcnt lgkmcnt(7)
    v_mfma_f32_32x32x16_bf16 v[112:127], v[176:179], v[80:83], 0
    s_lshl1_add_u32 s47, s41, 1
    s_and_b32 s47, s47, 7
    s_mul_i32 s47, s47, 81920
    s_add_u32 s47, s47, s59
    s_add_u32 s49, s63, 0x1e000
    s_add_u32 m0, s49, 0
    s_nop 0
    buffer_load_dwordx4 v144, s[24:27], s47 offen lds
    ds_read_b128 v[176:179], v228 offset:0
    v_mov_b32 v16, 0
    v_mov_b32 v17, 0
    v_mov_b32 v18, 0
    v_mov_b32 v19, 0
    s_waitcnt lgkmcnt(7)
    v_mfma_f32_32x32x16_bf16 v[128:143], v[180:183], v[80:83], 0
    s_add_u32 m0, s49, 1024
    s_nop 0
    buffer_load_dwordx4 v145, s[24:27], s47 offen lds
    ds_read_b128 v[180:183], v228 offset:8192
    v_mov_b32 v20, 0
    v_mov_b32 v21, 0
    v_mov_b32 v22, 0
    v_mov_b32 v23, 0
    s_waitcnt lgkmcnt(7)
    v_mfma_f32_32x32x16_bf16 v[112:127], v[184:187], v[84:87], v[112:127]
    s_add_u32 m0, s49, 2048
    s_nop 0
    buffer_load_dwordx4 v146, s[24:27], s47 offen lds
    ds_read_b128 v[184:187], v229 offset:0
    v_mov_b32 v24, 0
    v_mov_b32 v25, 0
    v_mov_b32 v26, 0
    v_mov_b32 v27, 0
    s_waitcnt lgkmcnt(7)
    v_mfma_f32_32x32x16_bf16 v[128:143], v[188:191], v[84:87], v[128:143]
    s_add_u32 m0, s49, 3072
    s_nop 0
    buffer_load_dwordx4 v147, s[24:27], s47 offen lds
    ds_read_b128 v[188:191], v229 offset:8192
    v_mov_b32 v28, 0
    v_mov_b32 v29, 0
    v_mov_b32 v30, 0
    v_mov_b32 v31, 0
    s_waitcnt lgkmcnt(7)
    v_mfma_f32_32x32x16_bf16 v[112:127], v[192:195], v[88:91], v[112:127]
    s_add_u32 m0, s49, 4096
    s_nop 0
    buffer_load_dwordx4 v148, s[24:27], s47 offen lds
    ds_read_b128 v[192:195], v230 offset:0
    v_mov_b32 v32, 0
    v_mov_b32 v33, 0
    v_mov_b32 v34, 0
    v_mov_b32 v35, 0
    s_waitcnt lgkmcnt(7)
    v_mfma_f32_32x32x16_bf16 v[128:143], v[196:199], v[88:91], v[128:143]
    s_add_u32 s46, s40, 0x208000
    s_add_u32 m0, s45, 0x8000
    s_nop 0
    buffer_load_dwordx4 v1, s[12:15], s46 offen nt lds
    ds_read_b128 v[196:199], v230 offset:8192
    v_mov_b32 v36, 0
    v_mov_b32 v37, 0
    v_mov_b32 v38, 0
    v_mov_b32 v39, 0
    s_waitcnt lgkmcnt(7)
    v_mfma_f32_32x32x16_bf16 v[112:127], v[200:203], v[92:95], v[112:127]
    s_add_u32 s46, s40, 0x209000
    s_add_u32 m0, s45, 0x9000
    s_nop 0
    buffer_load_dwordx4 v1, s[12:15], s46 offen nt lds
    ds_read_b128 v[200:203], v231 offset:0
    v_mov_b32 v40, 0
    v_mov_b32 v41, 0
    v_mov_b32 v42, 0
    v_mov_b32 v43, 0
    s_waitcnt lgkmcnt(7)
    v_mfma_f32_32x32x16_bf16 v[128:143], v[204:207], v[92:95], v[128:143]
    s_add_u32 s46, s40, 0x20a000
    s_add_u32 m0, s45, 0xa000
    s_nop 0
    buffer_load_dwordx4 v1, s[12:15], s46 offen nt lds
    ds_read_b128 v[204:207], v231 offset:8192
    v_mov_b32 v44, 0
    v_mov_b32 v45, 0
    v_mov_b32 v46, 0
    v_mov_b32 v47, 0
    s_waitcnt lgkmcnt(7)
    v_mfma_f32_32x32x16_bf16 v[112:127], v[176:179], v[96:99], v[112:127]
    s_add_u32 s46, s40, 0x20b000
    s_add_u32 m0, s45, 0xb000
    s_nop 0
    buffer_load_dwordx4 v1, s[12:15], s46 offen nt lds
    v_add_u32 v224, s53, v224
    v_add_u32 v232, s53, v232
    v_mov_b32 v48, 0
    v_mov_b32 v49, 0
    v_mov_b32 v50, 0
    v_mov_b32 v51, 0
    s_waitcnt lgkmcnt(6)
    v_mfma_f32_32x32x16_bf16 v[128:143], v[180:183], v[96:99], v[128:143]
    s_add_u32 s46, s40, 0x204000
    s_add_u32 m0, s45, 0xc000
    s_nop 0
    buffer_load_dwordx4 v2, s[16:19], s46 offen nt lds
    v_add_u32 v225, s53, v225
    v_add_u32 v233, s53, v233
    v_mov_b32 v52, 0
    v_mov_b32 v53, 0
    v_mov_b32 v54, 0
    v_mov_b32 v55, 0
    s_waitcnt lgkmcnt(5)
    v_mfma_f32_32x32x16_bf16 v[112:127], v[184:187], v[100:103], v[112:127]
    s_add_u32 s46, s40, 0x205000
    s_add_u32 m0, s45, 0xd000
    s_nop 0
    buffer_load_dwordx4 v2, s[16:19], s46 offen nt lds
    v_add_u32 v226, s53, v226
    v_add_u32 v234, s53, v234
    v_mov_b32 v56, 0
    v_mov_b32 v57, 0
    v_mov_b32 v58, 0
    v_mov_b32 v59, 0
    s_waitcnt lgkmcnt(4)
    v_mfma_f32_32x32x16_bf16 v[128:143], v[188:191], v[100:103], v[128:143]
    s_add_u32 s46, s40, 0x206000
    s_add_u32 m0, s45, 0xe000
    s_nop 0
    buffer_load_dwordx4 v2, s[16:19], s46 offen nt lds
    v_add_u32 v227, s53, v227
    v_add_u32 v235, s53, v235
    v_mov_b32 v60, 0
    v_mov_b32 v61, 0
    v_mov_b32 v62, 0
    v_mov_b32 v63, 0
    s_waitcnt lgkmcnt(3)
    v_mfma_f32_32x32x16_bf16 v[112:127], v[192:195], v[104:107], v[112:127]
    s_add_u32 s46, s40, 0x207000
    s_add_u32 m0, s45, 0xf000
    s_nop 0
    buffer_load_dwordx4 v2, s[16:19], s46 offen nt lds
    v_add_u32 v228, s53, v228
    v_mov_b32 v64, 0
    v_mov_b32 v65, 0
    v_mov_b32 v66, 0
    v_mov_b32 v67, 0
    s_waitcnt lgkmcnt(2)
    v_mfma_f32_32x32x16_bf16 v[128:143], v[196:199], v[104:107], v[128:143]
    v_add_u32 v229, s53, v229
    v_mov_b32 v68, 0
    v_mov_b32 v69, 0
    v_mov_b32 v70, 0
    v_mov_b32 v71, 0
    s_waitcnt lgkmcnt(1)
    v_mfma_f32_32x32x16_bf16 v[112:127], v[200:203], v[108:111], v[112:127]
    v_add_u32 v230, s53, v230
    v_mov_b32 v72, 0
    v_mov_b32 v73, 0
    v_mov_b32 v74, 0
    v_mov_b32 v75, 0
    s_waitcnt lgkmcnt(0)
    v_mfma_f32_32x32x16_bf16 v[128:143], v[204:207], v[108:111], v[128:143]
    v_add_u32 v231, s53, v231
    v_mov_b32 v76, 0
    v_mov_b32 v77, 0
    v_mov_b32 v78, 0
    v_mov_b32 v79, 0
    v_mov_b32 v238, 0
    v_mov_b32 v239, 0
    v_mov_b32 v244, v144
    v_mov_b32 v245, v145
    v_mov_b32 v246, v146
    v_mov_b32 v247, v147
    v_mov_b32 v248, v148
    s_mov_b32 s43, 4
    v_max_f32 v236, v112, v113
    v_max_f32 v237, v128, v129
    v_max3_f32 v236, v114, v115, v236
    v_max3_f32 v237, v130, v131, v237
    v_max3_f32 v236, v116, v117, v236
    v_max3_f32 v237, v132, v133, v237
    v_max3_f32 v236, v118, v119, v236
    v_max3_f32 v237, v134, v135, v237
    v_max3_f32 v236, v120, v121, v236
    v_max3_f32 v237, v136, v137, v237
    v_max3_f32 v236, v122, v123, v236
    v_max3_f32 v237, v138, v139, v237
    v_max3_f32 v236, v124, v125, v236
    v_max3_f32 v237, v140, v141, v237
    v_max3_f32 v236, v126, v127, v236
    v_max3_f32 v237, v142, v143, v237
    v_max_f32 v236, v236, v237
    s_waitcnt vmcnt(13) lgkmcnt(0)
    s_barrier
    ds_read_b128 v[176:179], v224 offset:0
    ds_read_b128 v[180:183], v224 offset:8192
    ds_read_b128 v[184:187], v225 offset:0
    ds_read_b128 v[188:191], v225 offset:8192
    ds_read_b128 v[192:195], v226 offset:0
    ds_read_b128 v[196:199], v226 offset:8192
    ds_read_b128 v[200:203], v227 offset:0
    ds_read_b128 v[204:207], v227 offset:8192
    v_mov_b32 v237, v236
    s_nop 1
    v_permlane32_swap_b32 v236, v237
    v_max_f32 v236, v236, v237
    v_sub_f32 v208, 0, v236
    v_sub_f32 v209, 0, v236
    v_sub_f32 v210, 0, v236
    v_sub_f32 v211, 0, v236
    v_sub_f32 v212, 0, v236
    v_sub_f32 v213, 0, v236
    v_sub_f32 v214, 0, v236
    v_sub_f32 v215, 0, v236
    v_sub_f32 v216, 0, v236
    v_sub_f32 v217, 0, v236
    v_sub_f32 v218, 0, v236
    v_sub_f32 v219, 0, v236
    v_sub_f32 v220, 0, v236
    v_sub_f32 v221, 0, v236
    v_sub_f32 v222, 0, v236
    v_sub_f32 v223, 0, v236
    v_sub_f32 v112, v112, v236
    v_sub_f32 v113, v113, v236
    v_sub_f32 v114, v114, v236
    v_sub_f32 v115, v115, v236
    v_sub_f32 v116, v116, v236
    v_sub_f32 v117, v117, v236
    v_sub_f32 v118, v118, v236
    v_sub_f32 v119, v119, v236
    v_sub_f32 v120, v120, v236
    v_sub_f32 v121, v121, v236
    v_sub_f32 v122, v122, v236
    v_sub_f32 v123, v123, v236
    v_sub_f32 v124, v124, v236
    v_sub_f32 v125, v125, v236
    v_sub_f32 v126, v126, v236
    v_sub_f32 v127, v127, v236
    v_sub_f32 v128, v128, v236
    v_sub_f32 v129, v129, v236
    v_sub_f32 v130, v130, v236
    v_sub_f32 v131, v131, v236
    v_sub_f32 v132, v132, v236
    v_sub_f32 v133, v133, v236
    v_sub_f32 v134, v134, v236
    v_sub_f32 v135, v135, v236
    v_sub_f32 v136, v136, v236
    v_sub_f32 v137, v137, v236
    v_sub_f32 v138, v138, v236
    v_sub_f32 v139, v139, v236
    v_sub_f32 v140, v140, v236
    v_sub_f32 v141, v141, v236
    v_sub_f32 v142, v142, v236
    v_sub_f32 v143, v143, v236
ATT_LOOP:
    s_add_u32 s54, s54, 1
    s_cmp_eq_u32 s54, 3
    s_cselect_b32 s54, 0, s54
    s_mov_b32 s53, 0x8000
    s_cselect_b32 s53, 0xffff0000, s53
    s_waitcnt lgkmcnt(7)
    v_mfma_f32_32x32x16_bf16 v[144:159], v[176:179], v[80:83], v[208:223]
    ds_read_b128 v[176:179], v228 offset:0
    v_exp_f32 v112, v112
    v_exp_f32 v113, v113
    v_exp_f32 v114, v114
    s_waitcnt lgkmcnt(7)
    v_mfma_f32_32x32x16_bf16 v[160:175], v[180:183], v[80:83], v[208:223]
    ds_read_b128 v[180:183], v228 offset:8192
    v_exp_f32 v115, v115
    v_add_f32 v238, v112, v238
    s_waitcnt lgkmcnt(7)
    v_mfma_f32_32x32x16_bf16 v[144:159], v[184:187], v[84:87], v[144:159]
    ds_read_b128 v[184:187], v229 offset:0
    v_add_f32 v239, v113, v239
    v_cvt_pk_bf16_f32 v112, v112, v113
    v_exp_f32 v116, v116
    v_exp_f32 v117, v117
    s_waitcnt lgkmcnt(7)
    v_mfma_f32_32x32x16_bf16 v[160:175], v[188:191], v[84:87], v[160:175]
    ds_read_b128 v[188:191], v229 offset:8192
    v_add_f32 v238, v114, v238
    v_add_f32 v239, v115, v239
    v_cvt_pk_bf16_f32 v113, v114, v115
    s_waitcnt lgkmcnt(7)
    v_mfma_f32_32x32x16_bf16 v[144:159], v[192:195], v[88:91], v[144:159]
    ds_read_b128 v[192:195], v230 offset:0
    v_exp_f32 v118, v118
    v_exp_f32 v119, v119
    v_add_f32 v238, v116, v238
    s_waitcnt lgkmcnt(7)
    v_mfma_f32_32x32x16_bf16 v[160:175], v[196:199], v[88:91], v[160:175]
    ds_read_b128 v[196:199], v230 offset:8192
    v_add_f32 v239, v117, v239
    v_cvt_pk_bf16_f32 v114, v116, v117
    v_exp_f32 v120, v120
    s_waitcnt lgkmcnt(7)
    v_mfma_f32_32x32x16_bf16 v[144:159], v[200:203], v[92:95], v[144:159]
    ds_read_b128 v[200:203], v231 offset:0
    v_exp_f32 v121, v121
    v_add_f32 v238, v118, v238
    v_add_f32 v239, v119, v239
    s_waitcnt lgkmcnt(7)
    v_mfma_f32_32x32x16_bf16 v[160:175], v[204:207], v[92:95], v[160:175]
    ds_read_b128 v[204:207], v231 offset:8192
    v_cvt_pk_bf16_f32 v115, v118, v119
    v_exp_f32 v122, v122
    v_exp_f32 v123, v123
    s_waitcnt lgkmcnt(7)
    v_mfma_f32_32x32x16_bf16 v[144:159], v[176:179], v[96:99], v[144:159]
    ds_read_b64_tr_b16 v[176:177], v232 offset:0
    ds_read_b64_tr_b16 v[178:179], v232 offset:1024
    v_add_f32 v238, v120, v238
    v_add_f32 v239, v121, v239
    v_cvt_pk_bf16_f32 v116, v120, v121
    v_exp_f32 v124, v124
    s_waitcnt lgkmcnt(8)
    v_mfma_f32_32x32x16_bf16 v[160:175], v[180:183], v[96:99], v[160:175]
    ds_read_b64_tr_b16 v[180:181], v233 offset:0
    ds_read_b64_tr_b16 v[182:183], v233 offset:1024
    v_exp_f32 v125, v125
    v_add_f32 v238, v122, v238
    v_add_f32 v239, v123, v239
    s_waitcnt lgkmcnt(9)
    v_mfma_f32_32x32x16_bf16 v[144:159], v[184:187], v[100:103], v[144:159]
    ds_read_b64_tr_b16 v[184:185], v234 offset:0
    ds_read_b64_tr_b16 v[186:187], v234 offset:1024
    v_add_u32 v224, s53, v224
    v_cvt_pk_bf16_f32 v117, v122, v123
    v_add_u32 v225, s53, v225
    v_exp_f32 v126, v126
    s_waitcnt lgkmcnt(10)
    v_mfma_f32_32x32x16_bf16 v[160:175], v[188:191], v[100:103], v[160:175]
    ds_read_b64_tr_b16 v[188:189], v235 offset:0
    ds_read_b64_tr_b16 v[190:191], v235 offset:1024
    v_add_u32 v226, s53, v226
    v_exp_f32 v127, v127
    s_waitcnt lgkmcnt(11)
    v_mfma_f32_32x32x16_bf16 v[144:159], v[192:195], v[104:107], v[144:159]
    ds_read_b64_tr_b16 v[192:193], v232 offset:4096
    ds_read_b64_tr_b16 v[194:195], v232 offset:5120
    v_add_u32 v227, s53, v227
    v_add_f32 v238, v124, v238
    v_add_u32 v228, s53, v228
    v_add_f32 v239, v125, v239
    v_add_u32 v229, s53, v229
    s_waitcnt lgkmcnt(12)
    v_mfma_f32_32x32x16_bf16 v[160:175], v[196:199], v[104:107], v[160:175]
    ds_read_b64_tr_b16 v[196:197], v233 offset:4096
    ds_read_b64_tr_b16 v[198:199], v233 offset:5120
    v_cvt_pk_bf16_f32 v118, v124, v125
    v_add_u32 v230, s53, v230
    v_exp_f32 v128, v128
    s_waitcnt lgkmcnt(13)
    v_mfma_f32_32x32x16_bf16 v[144:159], v[200:203], v[108:111], v[144:159]
    ds_read_b64_tr_b16 v[200:201], v234 offset:4096
    ds_read_b64_tr_b16 v[202:203], v234 offset:5120
    v_add_u32 v231, s53, v231
    v_exp_f32 v129, v129
    v_add_f32 v238, v126, v238
    v_add_f32 v239, v127, v239
    s_waitcnt lgkmcnt(14)
    v_mfma_f32_32x32x16_bf16 v[160:175], v[204:207], v[108:111], v[160:175]
    ds_read_b64_tr_b16 v[204:205], v235 offset:4096
    ds_read_b64_tr_b16 v[206:207], v235 offset:5120
    v_cvt_pk_bf16_f32 v119, v126, v127
    v_exp_f32 v130, v130
    v_exp_f32 v131, v131
    s_waitcnt lgkmcnt(14)
    v_mfma_f32_32x32x16_bf16 v[16:31], v[176:179], v[112:115], v[16:31]
    ds_read_b64_tr_b16 v[176:177], v232 offset:8192
    ds_read_b64_tr_b16 v[178:179], v232 offset:9216
    v_add_f32 v238, v128, v238
    v_add_f32 v239, v129, v239
    v_cvt_pk_bf16_f32 v128, v128, v129
    s_waitcnt lgkmcnt(14)
    v_mfma_f32_32x32x16_bf16 v[32:47], v[180:183], v[112:115], v[32:47]
    ds_read_b64_tr_b16 v[180:181], v233 offset:8192
    ds_read_b64_tr_b16 v[182:183], v233 offset:9216
    v_exp_f32 v132, v132
    v_exp_f32 v133, v133
    v_add_f32 v238, v130, v238
    s_waitcnt lgkmcnt(14)
    v_mfma_f32_32x32x16_bf16 v[48:63], v[184:187], v[112:115], v[48:63]
    ds_read_b64_tr_b16 v[184:185], v234 offset:8192
    ds_read_b64_tr_b16 v[186:187], v234 offset:9216
    v_add_f32 v239, v131, v239
    v_cvt_pk_bf16_f32 v129, v130, v131
    v_exp_f32 v134, v134
    s_waitcnt lgkmcnt(14)
    v_mfma_f32_32x32x16_bf16 v[64:79], v[188:191], v[112:115], v[64:79]
    ds_read_b64_tr_b16 v[188:189], v235 offset:8192
    ds_read_b64_tr_b16 v[190:191], v235 offset:9216
    v_exp_f32 v135, v135
    v_add_f32 v238, v132, v238
    v_add_f32 v239, v133, v239
    v_cvt_pk_bf16_f32 v130, v132, v133
    s_waitcnt lgkmcnt(14)
    v_mfma_f32_32x32x16_bf16 v[16:31], v[192:195], v[116:119], v[16:31]
    ds_read_b64_tr_b16 v[192:193], v232 offset:12288
    ds_read_b64_tr_b16 v[194:195], v232 offset:13312
    v_exp_f32 v136, v136
    v_exp_f32 v137, v137
    s_waitcnt lgkmcnt(14)
    v_mfma_f32_32x32x16_bf16 v[32:47], v[196:199], v[116:119], v[32:47]
    ds_read_b64_tr_b16 v[196:197], v233 offset:12288
    ds_read_b64_tr_b16 v[198:199], v233 offset:13312
    v_add_f32 v238, v134, v238
    v_add_f32 v239, v135, v239
    v_cvt_pk_bf16_f32 v131, v134, v135
    v_exp_f32 v138, v138
    s_waitcnt lgkmcnt(14)
    v_mfma_f32_32x32x16_bf16 v[48:63], v[200:203], v[116:119], v[48:63]
    ds_read_b64_tr_b16 v[200:201], v234 offset:12288
    ds_read_b64_tr_b16 v[202:203], v234 offset:13312
    v_exp_f32 v139, v139
    v_add_f32 v238, v136, v238
    v_add_f32 v239, v137, v239
    s_waitcnt lgkmcnt(14)
    v_mfma_f32_32x32x16_bf16 v[64:79], v[204:207], v[116:119], v[64:79]
    ds_read_b64_tr_b16 v[204:205], v235 offset:12288
    ds_read_b64_tr_b16 v[206:207], v235 offset:13312
    v_cvt_pk_bf16_f32 v132, v136, v137
    v_exp_f32 v140, v140
    v_exp_f32 v141, v141
    s_waitcnt lgkmcnt(14)
    v_mfma_f32_32x32x16_bf16 v[16:31], v[176:179], v[128:131], v[16:31]
    v_add_f32 v238, v138, v238
    v_add_f32 v239, v139, v239
    v_cvt_pk_bf16_f32 v133, v138, v139
    v_exp_f32 v142, v142
    s_waitcnt lgkmcnt(12)
    v_mfma_f32_32x32x16_bf16 v[32:47], v[180:183], v[128:131], v[32:47]
    v_exp_f32 v143, v143
    v_add_f32 v238, v140, v238
    s_waitcnt lgkmcnt(10)
    v_mfma_f32_32x32x16_bf16 v[48:63], v[184:187], v[128:131], v[48:63]
    v_add_f32 v239, v141, v239
    v_cvt_pk_bf16_f32 v134, v140, v141
    v_add_f32 v238, v142, v238
    v_add_f32 v239, v143, v239
    s_waitcnt vmcnt(0) lgkmcnt(0)
    s_barrier
    ds_read_b128 v[176:179], v224 offset:0
    ds_read_b128 v[180:183], v224 offset:8192
    ds_read_b128 v[184:187], v225 offset:0
    v_mfma_f32_32x32x16_bf16 v[64:79], v[188:191], v[128:131], v[64:79]
    ds_read_b128 v[188:191], v225 offset:8192
    v_cvt_pk_bf16_f32 v135, v142, v143
    v_max_f32 v236, v144, v145
    v_max_f32 v237, v160, v161
    v_max3_f32 v236, v146, v147, v236
    v_max3_f32 v237, v162, v163, v237
    v_mfma_f32_32x32x16_bf16 v[16:31], v[192:195], v[132:135], v[16:31]
    ds_read_b128 v[192:195], v226 offset:0
    v_max3_f32 v236, v148, v149, v236
    v_max3_f32 v237, v164, v165, v237
    v_max3_f32 v236, v150, v151, v236
    v_max3_f32 v237, v166, v167, v237
    v_mfma_f32_32x32x16_bf16 v[32:47], v[196:199], v[132:135], v[32:47]
    ds_read_b128 v[196:199], v226 offset:8192
    v_add_u32 v232, s53, v232
    v_add_u32 v233, s53, v233
    v_add_u32 v234, s53, v234
    v_add_u32 v235, s53, v235
    v_max3_f32 v236, v152, v153, v236
    v_mfma_f32_32x32x16_bf16 v[48:63], v[200:203], v[132:135], v[48:63]
    ds_read_b128 v[200:203], v227 offset:0
    v_max3_f32 v237, v168, v169, v237
    v_max3_f32 v236, v154, v155, v236
    v_max3_f32 v237, v170, v171, v237
    v_max3_f32 v236, v156, v157, v236
    v_mfma_f32_32x32x16_bf16 v[64:79], v[204:207], v[132:135], v[64:79]
    ds_read_b128 v[204:207], v227 offset:8192
    v_max3_f32 v237, v172, v173, v237
    v_max3_f32 v236, v158, v159, v236
    v_max3_f32 v237, v174, v175, v237
    v_max_f32 v236, v236, v237
    v_cmp_lt_f32 vcc, 0x41000000, v236
    s_cbranch_vccnz SLOW_A
BACK_A:
    s_sub_u32 s43, s43, 1
    s_cmp_eq_u32 s43, 0
    s_cbranch_scc1 ATT_LAST
    s_add_u32 s54, s54, 1
    s_cmp_eq_u32 s54, 3
    s_cselect_b32 s54, 0, s54
    s_mov_b32 s53, 0x8000
    s_cselect_b32 s53, 0xffff0000, s53
    s_waitcnt lgkmcnt(7)
    v_mfma_f32_32x32x16_bf16 v[112:127], v[176:179], v[80:83], v[208:223]
    ds_read_b128 v[176:179], v228 offset:0
    v_exp_f32 v144, v144
    v_exp_f32 v145, v145
    v_exp_f32 v146, v146
    s_waitcnt lgkmcnt(7)
    v_mfma_f32_32x32x16_bf16 v[128:143], v[180:183], v[80:83], v[208:223]
    ds_read_b128 v[180:183], v228 offset:8192
    v_exp_f32 v147, v147
    v_add_f32 v238, v144, v238
    s_waitcnt lgkmcnt(7)
    v_mfma_f32_32x32x16_bf16 v[112:127], v[184:187], v[84:87], v[112:127]
    ds_read_b128 v[184:187], v229 offset:0
    v_add_f32 v239, v145, v239
    v_cvt_pk_bf16_f32 v144, v144, v145
    v_exp_f32 v148, v148
    v_exp_f32 v149, v149
    s_waitcnt lgkmcnt(7)
    v_mfma_f32_32x32x16_bf16 v[128:143], v[188:191], v[84:87], v[128:143]
    ds_read_b128 v[188:191], v229 offset:8192
    v_add_f32 v238, v146, v238
    v_add_f32 v239, v147, v239
    v_cvt_pk_bf16_f32 v145, v146, v147
    s_waitcnt lgkmcnt(7)
    v_mfma_f32_32x32x16_bf16 v[112:127], v[192:195], v[88:91], v[112:127]
    ds_read_b128 v[192:195], v230 offset:0
    v_exp_f32 v150, v150
    v_exp_f32 v151, v151
    v_add_f32 v238, v148, v238
    s_waitcnt lgkmcnt(7)
    v_mfma_f32_32x32x16_bf16 v[128:143], v[196:199], v[88:91], v[128:143]
    ds_read_b128 v[196:199], v230 offset:8192
    v_add_f32 v239, v149, v239
    v_cvt_pk_bf16_f32 v146, v148, v149
    v_exp_f32 v152, v152
    s_waitcnt lgkmcnt(7)
    v_mfma_f32_32x32x16_bf16 v[112:127], v[200:203], v[92:95], v[112:127]
    ds_read_b128 v[200:203], v231 offset:0
    v_exp_f32 v153, v153
    v_add_f32 v238, v150, v238
    v_add_f32 v239, v151, v239
    s_waitcnt lgkmcnt(7)
    v_mfma_f32_32x32x16_bf16 v[128:143], v[204:207], v[92:95], v[128:143]
    ds_read_b128 v[204:207], v231 offset:8192
    v_cvt_pk_bf16_f32 v147, v150, v151
    v_exp_f32 v154, v154
    v_exp_f32 v155, v155
    s_waitcnt lgkmcnt(7)
    v_mfma_f32_32x32x16_bf16 v[112:127], v[176:179], v[96:99], v[112:127]
    ds_read_b64_tr_b16 v[176:177], v232 offset:0
    ds_read_b64_tr_b16 v[178:179], v232 offset:1024
    v_add_f32 v238, v152, v238
    v_add_f32 v239, v153, v239
    v_cvt_pk_bf16_f32 v148, v152, v153
    v_exp_f32 v156, v156
    s_waitcnt lgkmcnt(8)
    v_mfma_f32_32x32x16_bf16 v[128:143], v[180:183], v[96:99], v[128:143]
    ds_read_b64_tr_b16 v[180:181], v233 offset:0
    ds_read_b64_tr_b16 v[182:183], v233 offset:1024
    v_exp_f32 v157, v157
    v_add_f32 v238, v154, v238
    v_add_f32 v239, v155, v239
    s_waitcnt lgkmcnt(9)
    v_mfma_f32_32x32x16_bf16 v[112:127], v[184:187], v[100:103], v[112:127]
    ds_read_b64_tr_b16 v[184:185], v234 offset:0
    ds_read_b64_tr_b16 v[186:187], v234 offset:1024
    v_add_u32 v224, s53, v224
    v_cvt_pk_bf16_f32 v149, v154, v155
    v_add_u32 v225, s53, v225
    v_exp_f32 v158, v158
    s_waitcnt lgkmcnt(10)
    v_mfma_f32_32x32x16_bf16 v[128:143], v[188:191], v[100:103], v[128:143]
    ds_read_b64_tr_b16 v[188:189], v235 offset:0
    ds_read_b64_tr_b16 v[190:191], v235 offset:1024
    v_add_u32 v226, s53, v226
    v_exp_f32 v159, v159
    s_waitcnt lgkmcnt(11)
    v_mfma_f32_32x32x16_bf16 v[112:127], v[192:195], v[104:107], v[112:127]
    ds_read_b64_tr_b16 v[192:193], v232 offset:4096
    ds_read_b64_tr_b16 v[194:195], v232 offset:5120
    v_add_u32 v227, s53, v227
    v_add_f32 v238, v156, v238
    v_add_u32 v228, s53, v228
    v_add_f32 v239, v157, v239
    v_add_u32 v229, s53, v229
    s_waitcnt lgkmcnt(12)
    v_mfma_f32_32x32x16_bf16 v[128:143], v[196:199], v[104:107], v[128:143]
    ds_read_b64_tr_b16 v[196:197], v233 offset:4096
    ds_read_b64_tr_b16 v[198:199], v233 offset:5120
    v_cvt_pk_bf16_f32 v150, v156, v157
    v_add_u32 v230, s53, v230
    v_exp_f32 v160, v160
    s_waitcnt lgkmcnt(13)
    v_mfma_f32_32x32x16_bf16 v[112:127], v[200:203], v[108:111], v[112:127]
    ds_read_b64_tr_b16 v[200:201], v234 offset:4096
    ds_read_b64_tr_b16 v[202:203], v234 offset:5120
    v_add_u32 v231, s53, v231
    v_exp_f32 v161, v161
    v_add_f32 v238, v158, v238
    v_add_f32 v239, v159, v239
    s_waitcnt lgkmcnt(14)
    v_mfma_f32_32x32x16_bf16 v[128:143], v[204:207], v[108:111], v[128:143]
    ds_read_b64_tr_b16 v[204:205], v235 offset:4096
    ds_read_b64_tr_b16 v[206:207], v235 offset:5120
    v_cvt_pk_bf16_f32 v151, v158, v159
    v_exp_f32 v162, v162
    v_exp_f32 v163, v163
    s_waitcnt lgkmcnt(14)
    v_mfma_f32_32x32x16_bf16 v[16:31], v[176:179], v[144:147], v[16:31]
    ds_read_b64_tr_b16 v[176:177], v232 offset:8192
    ds_read_b64_tr_b16 v[178:179], v232 offset:9216
    v_add_f32 v238, v160, v238
    v_add_f32 v239, v161, v239
    v_cvt_pk_bf16_f32 v160, v160, v161
    s_waitcnt lgkmcnt(14)
    v_mfma_f32_32x32x16_bf16 v[32:47], v[180:183], v[144:147], v[32:47]
    ds_read_b64_tr_b16 v[180:181], v233 offset:8192
    ds_read_b64_tr_b16 v[182:183], v233 offset:9216
    v_exp_f32 v164, v164
    v_exp_f32 v165, v165
    v_add_f32 v238, v162, v238
    s_waitcnt lgkmcnt(14)
    v_mfma_f32_32x32x16_bf16 v[48:63], v[184:187], v[144:147], v[48:63]
    ds_read_b64_tr_b16 v[184:185], v234 offset:8192
    ds_read_b64_tr_b16 v[186:187], v234 offset:9216
    v_add_f32 v239, v163, v239
    v_cvt_pk_bf16_f32 v161, v162, v163
    v_exp_f32 v166, v166
    s_waitcnt lgkmcnt(14)
    v_mfma_f32_32x32x16_bf16 v[64:79], v[188:191], v[144:147], v[64:79]
    ds_read_b64_tr_b16 v[188:189], v235 offset:8192
    ds_read_b64_tr_b16 v[190:191], v235 offset:9216
    v_exp_f32 v167, v167
    v_add_f32 v238, v164, v238
    v_add_f32 v239, v165, v239
    v_cvt_pk_bf16_f32 v162, v164, v165
    s_waitcnt lgkmcnt(14)
    v_mfma_f32_32x32x16_bf16 v[16:31], v[192:195], v[148:151], v[16:31]
    ds_read_b64_tr_b16 v[192:193], v232 offset:12288
    ds_read_b64_tr_b16 v[194:195], v232 offset:13312
    v_exp_f32 v168, v168
    v_exp_f32 v169, v169
    s_waitcnt lgkmcnt(14)
    v_mfma_f32_32x32x16_bf16 v[32:47], v[196:199], v[148:151], v[32:47]
    ds_read_b64_tr_b16 v[196:197], v233 offset:12288
    ds_read_b64_tr_b16 v[198:199], v233 offset:13312
    v_add_f32 v238, v166, v238
    v_add_f32 v239, v167, v239
    v_cvt_pk_bf16_f32 v163, v166, v167
    v_exp_f32 v170, v170
    s_waitcnt lgkmcnt(14)
    v_mfma_f32_32x32x16_bf16 v[48:63], v[200:203], v[148:151], v[48:63]
    ds_read_b64_tr_b16 v[200:201], v234 offset:12288
    ds_read_b64_tr_b16 v[202:203], v234 offset:13312
    v_exp_f32 v171, v171
    v_add_f32 v238, v168, v238
    v_add_f32 v239, v169, v239
    s_waitcnt lgkmcnt(14)
    v_mfma_f32_32x32x16_bf16 v[64:79], v[204:207], v[148:151], v[64:79]
    ds_read_b64_tr_b16 v[204:205], v235 offset:12288
    ds_read_b64_tr_b16 v[206:207], v235 offset:13312
    v_cvt_pk_bf16_f32 v164, v168, v169
    v_exp_f32 v172, v172
    v_exp_f32 v173, v173
    s_waitcnt lgkmcnt(14)
    v_mfma_f32_32x32x16_bf16 v[16:31], v[176:179], v[160:163], v[16:31]
    v_add_f32 v238, v170, v238
    v_add_f32 v239, v171, v239
    v_cvt_pk_bf16_f32 v165, v170, v171
    v_exp_f32 v174, v174
    s_waitcnt lgkmcnt(12)
    v_mfma_f32_32x32x16_bf16 v[32:47], v[180:183], v[160:163], v[32:47]
    v_exp_f32 v175, v175
    v_add_f32 v238, v172, v238
    s_waitcnt lgkmcnt(10)
    v_mfma_f32_32x32x16_bf16 v[48:63], v[184:187], v[160:163], v[48:63]
    v_add_f32 v239, v173, v239
    v_cvt_pk_bf16_f32 v166, v172, v173
    v_add_f32 v238, v174, v238
    v_add_f32 v239, v175, v239
    s_waitcnt vmcnt(0) lgkmcnt(0)
    s_barrier
    ds_read_b128 v[176:179], v224 offset:0
    ds_read_b128 v[180:183], v224 offset:8192
    ds_read_b128 v[184:187], v225 offset:0
    v_mfma_f32_32x32x16_bf16 v[64:79], v[188:191], v[160:163], v[64:79]
    ds_read_b128 v[188:191], v225 offset:8192
    v_cvt_pk_bf16_f32 v167, v174, v175
    v_max_f32 v236, v112, v113
    v_max_f32 v237, v128, v129
    v_max3_f32 v236, v114, v115, v236
    v_max3_f32 v237, v130, v131, v237
    v_mfma_f32_32x32x16_bf16 v[16:31], v[192:195], v[164:167], v[16:31]
    ds_read_b128 v[192:195], v226 offset:0
    v_max3_f32 v236, v116, v117, v236
    v_max3_f32 v237, v132, v133, v237
    v_max3_f32 v236, v118, v119, v236
    v_max3_f32 v237, v134, v135, v237
    v_mfma_f32_32x32x16_bf16 v[32:47], v[196:199], v[164:167], v[32:47]
    ds_read_b128 v[196:199], v226 offset:8192
    v_add_u32 v232, s53, v232
    v_add_u32 v233, s53, v233
    v_add_u32 v234, s53, v234
    v_add_u32 v235, s53, v235
    v_max3_f32 v236, v120, v121, v236
    v_mfma_f32_32x32x16_bf16 v[48:63], v[200:203], v[164:167], v[48:63]
    ds_read_b128 v[200:203], v227 offset:0
    v_max3_f32 v237, v136, v137, v237
    v_max3_f32 v236, v122, v123, v236
    v_max3_f32 v237, v138, v139, v237
    v_max3_f32 v236, v124, v125, v236
    v_mfma_f32_32x32x16_bf16 v[64:79], v[204:207], v[164:167], v[64:79]
    ds_read_b128 v[204:207], v227 offset:8192
    v_max3_f32 v237, v140, v141, v237
    v_max3_f32 v236, v126, v127, v236
    v_max3_f32 v237, v142, v143, v237
    v_max_f32 v236, v236, v237
    v_cmp_lt_f32 vcc, 0x41000000, v236
    s_cbranch_vccnz SLOW_B
BACK_B:
    s_branch ATT_LOOP
ATT_LAST:
    ds_read_b64_tr_b16 v[176:177], v232 offset:0
    ds_read_b64_tr_b16 v[178:179], v232 offset:1024
    ds_read_b64_tr_b16 v[180:181], v233 offset:0
    ds_read_b64_tr_b16 v[182:183], v233 offset:1024
    ds_read_b64_tr_b16 v[184:185], v234 offset:0
    ds_read_b64_tr_b16 v[186:187], v234 offset:1024
    ds_read_b64_tr_b16 v[188:189], v235 offset:0
    ds_read_b64_tr_b16 v[190:191], v235 offset:1024
    ds_read_b64_tr_b16 v[192:193], v232 offset:4096
    ds_read_b64_tr_b16 v[194:195], v232 offset:5120
    ds_read_b64_tr_b16 v[196:197], v233 offset:4096
    ds_read_b64_tr_b16 v[198:199], v233 offset:5120
    ds_read_b64_tr_b16 v[200:201], v234 offset:4096
    ds_read_b64_tr_b16 v[202:203], v234 offset:5120
    ds_read_b64_tr_b16 v[204:205], v235 offset:4096
    ds_read_b64_tr_b16 v[206:207], v235 offset:5120
    s_lshl4_add_u32 s46, s5, s41
    s_lshl_b32 s46, s46, 15
    s_add_u32 s98, s56, s46
    s_add_u32 s99, s98, 0x1000
    v_exp_f32 v144, v144
    v_exp_f32 v145, v145
    v_exp_f32 v146, v146
    v_exp_f32 v147, v147
    v_add_f32 v238, v144, v238
    v_add_f32 v239, v145, v239
    v_cvt_pk_bf16_f32 v144, v144, v145
    v_exp_f32 v148, v148
    v_exp_f32 v149, v149
    v_add_f32 v238, v146, v238
    v_add_f32 v239, v147, v239
    v_cvt_pk_bf16_f32 v145, v146, v147
    v_exp_f32 v150, v150
    v_exp_f32 v151, v151
    v_add_f32 v238, v148, v238
    v_add_f32 v239, v149, v239
    v_cvt_pk_bf16_f32 v146, v148, v149
    v_exp_f32 v152, v152
    v_exp_f32 v153, v153
    v_add_f32 v238, v150, v238
    v_add_f32 v239, v151, v239
    v_cvt_pk_bf16_f32 v147, v150, v151
    s_waitcnt lgkmcnt(14)
    s_nop 0
    v_mfma_f32_32x32x16_bf16 v[16:31], v[176:179], v[144:147], v[16:31]
    ds_read_b64_tr_b16 v[176:177], v232 offset:8192
    ds_read_b64_tr_b16 v[178:179], v232 offset:9216
    v_exp_f32 v154, v154
    v_exp_f32 v155, v155
    v_add_f32 v238, v152, v238
    v_add_f32 v239, v153, v239
    v_cvt_pk_bf16_f32 v148, v152, v153
    s_waitcnt lgkmcnt(14)
    v_mfma_f32_32x32x16_bf16 v[32:47], v[180:183], v[144:147], v[32:47]
    ds_read_b64_tr_b16 v[180:181], v232 offset:12288
    ds_read_b64_tr_b16 v[182:183], v232 offset:13312
    v_exp_f32 v156, v156
    v_exp_f32 v157, v157
    v_add_f32 v238, v154, v238
    v_add_f32 v239, v155, v239
    v_cvt_pk_bf16_f32 v149, v154, v155
    s_waitcnt lgkmcnt(14)
    v_mfma_f32_32x32x16_bf16 v[48:63], v[184:187], v[144:147], v[48:63]
    ds_read_b64_tr_b16 v[184:185], v233 offset:8192
    ds_read_b64_tr_b16 v[186:187], v233 offset:9216
    v_exp_f32 v158, v158
    v_exp_f32 v159, v159
    v_add_f32 v238, v156, v238
    v_add_f32 v239, v157, v239
    v_cvt_pk_bf16_f32 v150, v156, v157
    v_exp_f32 v160, v160
    v_exp_f32 v161, v161
    v_add_f32 v238, v158, v238
    v_add_f32 v239, v159, v239
    v_cvt_pk_bf16_f32 v151, v158, v159
    s_waitcnt lgkmcnt(14)
    v_mfma_f32_32x32x16_bf16 v[64:79], v[188:191], v[144:147], v[64:79]
    ds_read_b64_tr_b16 v[188:189], v233 offset:12288
    ds_read_b64_tr_b16 v[190:191], v233 offset:13312
    v_exp_f32 v162, v162
    v_exp_f32 v163, v163
    v_add_f32 v238, v160, v238
    v_add_f32 v239, v161, v239
    v_cvt_pk_bf16_f32 v160, v160, v161
    s_waitcnt lgkmcnt(14)
    v_mfma_f32_32x32x16_bf16 v[16:31], v[192:195], v[148:151], v[16:31]
    ds_read_b64_tr_b16 v[192:193], v234 offset:8192
    ds_read_b64_tr_b16 v[194:195], v234 offset:9216
    v_exp_f32 v164, v164
    v_exp_f32 v165, v165
    v_add_f32 v238, v162, v238
    v_add_f32 v239, v163, v239
    v_cvt_pk_bf16_f32 v161, v162, v163
    v_exp_f32 v166, v166
    v_exp_f32 v167, v167
    v_add_f32 v238, v164, v238
    v_add_f32 v239, v165, v239
    v_cvt_pk_bf16_f32 v162, v164, v165
    s_waitcnt lgkmcnt(14)
    v_mfma_f32_32x32x16_bf16 v[32:47], v[196:199], v[148:151], v[32:47]
    ds_read_b64_tr_b16 v[196:197], v234 offset:12288
    ds_read_b64_tr_b16 v[198:199], v234 offset:13312
    v_exp_f32 v168, v168
    v_exp_f32 v169, v169
    v_add_f32 v238, v166, v238
    v_add_f32 v239, v167, v239
    v_cvt_pk_bf16_f32 v163, v166, v167
    s_waitcnt lgkmcnt(14)
    v_mfma_f32_32x32x16_bf16 v[48:63], v[200:203], v[148:151], v[48:63]
    ds_read_b64_tr_b16 v[200:201], v235 offset:8192
    ds_read_b64_tr_b16 v[202:203], v235 offset:9216
    v_exp_f32 v170, v170
    v_exp_f32 v171, v171
    v_add_f32 v238, v168, v238
    v_add_f32 v239, v169, v239
    v_cvt_pk_bf16_f32 v164, v168, v169
    v_exp_f32 v172, v172
    v_exp_f32 v173, v173
    v_add_f32 v238, v170, v238
    v_add_f32 v239, v171, v239
    v_cvt_pk_bf16_f32 v165, v170, v171
    s_waitcnt lgkmcnt(14)
    v_mfma_f32_32x32x16_bf16 v[64:79], v[204:207], v[148:151], v[64:79]
    ds_read_b64_tr_b16 v[204:205], v235 offset:12288
    ds_read_b64_tr_b16 v[206:207], v235 offset:13312
    v_exp_f32 v174, v174
    v_exp_f32 v175, v175
    v_add_f32 v238, v172, v238
    v_add_f32 v239, v173, v239
    v_cvt_pk_bf16_f32 v166, v172, v173
    v_add_f32 v238, v174, v238
    v_add_f32 v239, v175, v239
    v_cvt_pk_bf16_f32 v167, v174, v175
    v_add_f32 v238, v238, v239
    v_mov_b32 v237, v238
    s_waitcnt lgkmcnt(14)
    v_mfma_f32_32x32x16_bf16 v[16:31], v[176:179], v[160:163], v[16:31]
    v_permlane32_swap_b32 v238, v237
    v_add_f32 v238, v238, v237
    v_rcp_f32 v238, v238
    s_waitcnt lgkmcnt(12)
    v_mfma_f32_32x32x16_bf16 v[16:31], v[180:183], v[164:167], v[16:31]
    s_waitcnt lgkmcnt(0)
    s_cmp_lg_u32 s5, 0
    s_nop 2
    s_cbranch_scc1 G1_FIN
    s_barrier
    s_setprio 1
    v_mfma_f32_32x32x16_bf16 v[32:47], v[184:187], v[160:163], v[32:47]
    s_add_u32 s46, s40, 0x20c000
    s_add_u32 m0, s45, 0x10000
    s_nop 0
    buffer_load_dwordx4 v1, s[12:15], s46 offen nt lds
    s_add_u32 s46, s40, 0x20d000
    s_add_u32 m0, s45, 0x11000
    s_nop 0
    buffer_load_dwordx4 v1, s[12:15], s46 offen nt lds
    s_add_u32 s46, s40, 0x20e000
    s_add_u32 m0, s45, 0x12000
    s_nop 0
    buffer_load_dwordx4 v1, s[12:15], s46 offen nt lds
    s_add_u32 s46, s40, 0x20f000
    s_add_u32 m0, s45, 0x13000
    s_nop 0
    buffer_load_dwordx4 v1, s[12:15], s46 offen nt lds
    v_mfma_f32_32x32x16_bf16 v[32:47], v[188:191], v[164:167], v[32:47]
    s_add_u32 s46, s40, 0x208000
    s_add_u32 m0, s45, 0x14000
    s_nop 0
    buffer_load_dwordx4 v2, s[16:19], s46 offen nt lds
    s_add_u32 s46, s40, 0x209000
    s_add_u32 m0, s45, 0x15000
    s_nop 0
    buffer_load_dwordx4 v2, s[16:19], s46 offen nt lds
    s_add_u32 s46, s40, 0x20a000
    s_add_u32 m0, s45, 0x16000
    s_nop 0
    buffer_load_dwordx4 v2, s[16:19], s46 offen nt lds
    s_add_u32 s46, s40, 0x20b000
    s_add_u32 m0, s45, 0x17000
    s_nop 0
    buffer_load_dwordx4 v2, s[16:19], s46 offen nt lds
    v_mfma_f32_32x32x16_bf16 v[48:63], v[192:195], v[160:163], v[48:63]
    v_mul_f32 v16, v238, v16
    v_mul_f32 v17, v238, v17
    v_mul_f32 v18, v238, v18
    v_mul_f32 v19, v238, v19
    v_mul_f32 v20, v238, v20
    v_mul_f32 v21, v238, v21
    v_mul_f32 v22, v238, v22
    v_mul_f32 v23, v238, v23
    v_cvt_pk_bf16_f32 v96, v16, v17
    v_cvt_pk_bf16_f32 v97, v18, v19
    v_cvt_pk_bf16_f32 v98, v20, v21
    v_cvt_pk_bf16_f32 v99, v22, v23
    buffer_store_dwordx4 v[96:99], v13, s[32:35], s98 offen offset:0 sc1
    v_mfma_f32_32x32x16_bf16 v[48:63], v[196:199], v[164:167], v[48:63]
    v_mul_f32 v24, v238, v24
    v_mul_f32 v25, v238, v25
    v_mul_f32 v26, v238, v26
    v_mul_f32 v27, v238, v27
    v_mul_f32 v28, v238, v28
    v_mul_f32 v29, v238, v29
    v_mul_f32 v30, v238, v30
    v_mul_f32 v31, v238, v31
    v_cvt_pk_bf16_f32 v100, v24, v25
    v_cvt_pk_bf16_f32 v101, v26, v27
    v_cvt_pk_bf16_f32 v102, v28, v29
    v_cvt_pk_bf16_f32 v103, v30, v31
    buffer_store_dwordx4 v[100:103], v13, s[32:35], s98 offen offset:1024 sc1
    v_mfma_f32_32x32x16_bf16 v[64:79], v[200:203], v[160:163], v[64:79]
    v_mul_f32 v32, v238, v32
    v_mul_f32 v33, v238, v33
    v_mul_f32 v34, v238, v34
    v_mul_f32 v35, v238, v35
    v_mul_f32 v36, v238, v36
    v_mul_f32 v37, v238, v37
    v_mul_f32 v38, v238, v38
    v_mul_f32 v39, v238, v39
    v_cvt_pk_bf16_f32 v104, v32, v33
    v_cvt_pk_bf16_f32 v105, v34, v35
    v_cvt_pk_bf16_f32 v106, v36, v37
    v_cvt_pk_bf16_f32 v107, v38, v39
    buffer_store_dwordx4 v[104:107], v13, s[32:35], s98 offen offset:2048 sc1
    v_mfma_f32_32x32x16_bf16 v[64:79], v[204:207], v[164:167], v[64:79]
    v_mul_f32 v40, v238, v40
    v_mul_f32 v41, v238, v41
    v_mul_f32 v42, v238, v42
    v_mul_f32 v43, v238, v43
    v_mul_f32 v44, v238, v44
    v_mul_f32 v45, v238, v45
    v_mul_f32 v46, v238, v46
    v_mul_f32 v47, v238, v47
    v_cvt_pk_bf16_f32 v108, v40, v41
    v_cvt_pk_bf16_f32 v109, v42, v43
    v_cvt_pk_bf16_f32 v110, v44, v45
    v_cvt_pk_bf16_f32 v111, v46, v47
    buffer_store_dwordx4 v[108:111], v13, s[32:35], s98 offen offset:3072 sc1
    v_mul_f32 v48, v238, v48
    v_mul_f32 v49, v238, v49
    v_mul_f32 v50, v238, v50
    v_mul_f32 v51, v238, v51
    v_mul_f32 v52, v238, v52
    v_mul_f32 v53, v238, v53
    v_mul_f32 v54, v238, v54
    v_mul_f32 v55, v238, v55
    v_cvt_pk_bf16_f32 v112, v48, v49
    v_cvt_pk_bf16_f32 v113, v50, v51
    v_cvt_pk_bf16_f32 v114, v52, v53
    v_cvt_pk_bf16_f32 v115, v54, v55
    buffer_store_dwordx4 v[112:115], v13, s[32:35], s99 offen offset:0 sc1
    v_mul_f32 v56, v238, v56
    v_mul_f32 v57, v238, v57
    v_mul_f32 v58, v238, v58
    v_mul_f32 v59, v238, v59
    v_mul_f32 v60, v238, v60
    v_mul_f32 v61, v238, v61
    v_mul_f32 v62, v238, v62
    v_mul_f32 v63, v238, v63
    v_cvt_pk_bf16_f32 v116, v56, v57
    v_cvt_pk_bf16_f32 v117, v58, v59
    v_cvt_pk_bf16_f32 v118, v60, v61
    v_cvt_pk_bf16_f32 v119, v62, v63
    buffer_store_dwordx4 v[116:119], v13, s[32:35], s99 offen offset:1024 sc1
    v_mul_f32 v64, v238, v64
    v_mul_f32 v65, v238, v65
    v_mul_f32 v66, v238, v66
    v_mul_f32 v67, v238, v67
    v_mul_f32 v68, v238, v68
    v_mul_f32 v69, v238, v69
    v_mul_f32 v70, v238, v70
    v_mul_f32 v71, v238, v71
    v_cvt_pk_bf16_f32 v120, v64, v65
    v_cvt_pk_bf16_f32 v121, v66, v67
    v_cvt_pk_bf16_f32 v122, v68, v69
    v_cvt_pk_bf16_f32 v123, v70, v71
    buffer_store_dwordx4 v[120:123], v13, s[32:35], s99 offen offset:2048 sc1
    v_mul_f32 v72, v238, v72
    v_mul_f32 v73, v238, v73
    v_mul_f32 v74, v238, v74
    v_mul_f32 v75, v238, v75
    v_mul_f32 v76, v238, v76
    v_mul_f32 v77, v238, v77
    v_mul_f32 v78, v238, v78
    v_mul_f32 v79, v238, v79
    v_cvt_pk_bf16_f32 v124, v72, v73
    v_cvt_pk_bf16_f32 v125, v74, v75
    v_cvt_pk_bf16_f32 v126, v76, v77
    v_cvt_pk_bf16_f32 v127, v78, v79
    buffer_store_dwordx4 v[124:127], v13, s[32:35], s99 offen offset:3072 sc1
    v_lshrrev_b32 v224, 5, v0
    v_lshl_add_u32 v224, v224, 9, v5
    v_add_u32 v224, 0x19000, v224
    s_sub_u32 s46, s42, s4
    s_add_u32 s47, s46, 0
    s_and_b32 s47, s47, 3
    s_lshl_b32 s47, s47, 6
    v_add_u32 v5, s47, v224
    s_add_u32 s47, s46, 1
    s_and_b32 s47, s47, 3
    s_lshl_b32 s47, s47, 6
    v_add_u32 v6, s47, v224
    s_add_u32 s47, s46, 2
    s_and_b32 s47, s47, 3
    s_lshl_b32 s47, s47, 6
    v_add_u32 v7, s47, v224
    s_add_u32 s47, s46, 3
    s_and_b32 s47, s47, 3
    s_lshl_b32 s47, s47, 6
    v_add_u32 v8, s47, v224
    v_add_u32 v9, 0x100, v224
    ds_read_b64_tr_b16 v[224:225], v5 offset:0
    ds_read_b64_tr_b16 v[226:227], v5 offset:1280
    ds_read_b64_tr_b16 v[228:229], v6 offset:0
    ds_read_b64_tr_b16 v[230:231], v6 offset:1280
    ds_read_b64_tr_b16 v[232:233], v7 offset:0
    ds_read_b64_tr_b16 v[234:235], v7 offset:1280
    ds_read_b64_tr_b16 v[236:237], v8 offset:0
    ds_read_b64_tr_b16 v[238:239], v8 offset:1280
    ds_read_b64_tr_b16 v[240:241], v9 offset:0
    ds_read_b64_tr_b16 v[242:243], v9 offset:1280
    s_waitcnt lgkmcnt(8)
    v_mfma_f32_32x32x16_bf16 v[16:31], v[224:227], v[96:99], 0
    ds_read_b64_tr_b16 v[224:225], v5 offset:5120
    ds_read_b64_tr_b16 v[226:227], v5 offset:6400
    s_waitcnt lgkmcnt(8)
    v_mfma_f32_32x32x16_bf16 v[32:47], v[228:231], v[96:99], 0
    ds_read_b64_tr_b16 v[228:229], v6 offset:5120
    ds_read_b64_tr_b16 v[230:231], v6 offset:6400
    s_waitcnt lgkmcnt(8)
    v_mfma_f32_32x32x16_bf16 v[48:63], v[232:235], v[96:99], 0
    ds_read_b64_tr_b16 v[232:233], v7 offset:5120
    ds_read_b64_tr_b16 v[234:235], v7 offset:6400
    s_waitcnt lgkmcnt(8)
    v_mfma_f32_32x32x16_bf16 v[64:79], v[236:239], v[96:99], 0
    ds_read_b64_tr_b16 v[236:237], v8 offset:5120
    ds_read_b64_tr_b16 v[238:239], v8 offset:6400
    s_waitcnt lgkmcnt(8)
    v_mfma_f32_32x32x16_bf16 v[80:95], v[240:243], v[96:99], 0
    ds_read_b64_tr_b16 v[240:241], v9 offset:5120
    ds_read_b64_tr_b16 v[242:243], v9 offset:6400
    s_waitcnt lgkmcnt(8)
    v_mfma_f32_32x32x16_bf16 v[16:31], v[224:227], v[100:103], v[16:31]
    s_waitcnt lgkmcnt(6)
    v_mfma_f32_32x32x16_bf16 v[32:47], v[228:231], v[100:103], v[32:47]
    s_waitcnt lgkmcnt(4)
    v_mfma_f32_32x32x16_bf16 v[48:63], v[232:235], v[100:103], v[48:63]
    s_waitcnt lgkmcnt(2)
    v_mfma_f32_32x32x16_bf16 v[64:79], v[236:239], v[100:103], v[64:79]
    s_waitcnt lgkmcnt(0)
    v_mfma_f32_32x32x16_bf16 v[80:95], v[240:243], v[100:103], v[80:95]
    s_barrier
    ds_read_b64_tr_b16 v[224:225], v5 offset:10240
    ds_read_b64_tr_b16 v[226:227], v5 offset:11520
    ds_read_b64_tr_b16 v[228:229], v6 offset:10240
    ds_read_b64_tr_b16 v[230:231], v6 offset:11520
    ds_read_b64_tr_b16 v[232:233], v7 offset:10240
    ds_read_b64_tr_b16 v[234:235], v7 offset:11520
    ds_read_b64_tr_b16 v[236:237], v8 offset:10240
    ds_read_b64_tr_b16 v[238:239], v8 offset:11520
    ds_read_b64_tr_b16 v[240:241], v9 offset:10240
    ds_read_b64_tr_b16 v[242:243], v9 offset:11520
    s_waitcnt lgkmcnt(8)
    v_mfma_f32_32x32x16_bf16 v[16:31], v[224:227], v[104:107], v[16:31]
    ds_read_b64_tr_b16 v[224:225], v5 offset:15360
    ds_read_b64_tr_b16 v[226:227], v5 offset:16640
    s_waitcnt lgkmcnt(8)
    v_mfma_f32_32x32x16_bf16 v[32:47], v[228:231], v[104:107], v[32:47]
    ds_read_b64_tr_b16 v[228:229], v6 offset:15360
    ds_read_b64_tr_b16 v[230:231], v6 offset:16640
    s_waitcnt lgkmcnt(8)
    v_mfma_f32_32x32x16_bf16 v[48:63], v[232:235], v[104:107], v[48:63]
    ds_read_b64_tr_b16 v[232:233], v7 offset:15360
    ds_read_b64_tr_b16 v[234:235], v7 offset:16640
    s_add_u32 s46, s40, 0x210000
    s_add_u32 m0, s45, 0x0
    s_nop 0
    buffer_load_dwordx4 v1, s[12:15], s46 offen nt lds
    s_add_u32 s46, s40, 0x211000
    s_add_u32 m0, s45, 0x1000
    s_nop 0
    buffer_load_dwordx4 v1, s[12:15], s46 offen nt lds
    s_add_u32 s46, s40, 0x212000
    s_add_u32 m0, s45, 0x2000
    s_nop 0
    buffer_load_dwordx4 v1, s[12:15], s46 offen nt lds
    s_waitcnt lgkmcnt(8)
    v_mfma_f32_32x32x16_bf16 v[64:79], v[236:239], v[104:107], v[64:79]
    ds_read_b64_tr_b16 v[236:237], v8 offset:15360
    ds_read_b64_tr_b16 v[238:239], v8 offset:16640
    s_add_u32 s46, s40, 0x213000
    s_add_u32 m0, s45, 0x3000
    s_nop 0
    buffer_load_dwordx4 v1, s[12:15], s46 offen nt lds
    s_add_u32 s46, s40, 0x20c000
    s_add_u32 m0, s45, 0x4000
    s_nop 0
    buffer_load_dwordx4 v2, s[16:19], s46 offen nt lds
    s_add_u32 s46, s40, 0x20d000
    s_add_u32 m0, s45, 0x5000
    s_nop 0
    buffer_load_dwordx4 v2, s[16:19], s46 offen nt lds
    s_waitcnt lgkmcnt(8)
    v_mfma_f32_32x32x16_bf16 v[80:95], v[240:243], v[104:107], v[80:95]
    ds_read_b64_tr_b16 v[240:241], v9 offset:15360
    ds_read_b64_tr_b16 v[242:243], v9 offset:16640
    s_add_u32 s46, s40, 0x20e000
    s_add_u32 m0, s45, 0x6000
    s_nop 0
    buffer_load_dwordx4 v2, s[16:19], s46 offen nt lds
    s_add_u32 s46, s40, 0x20f000
    s_add_u32 m0, s45, 0x7000
    s_nop 0
    buffer_load_dwordx4 v2, s[16:19], s46 offen nt lds
    buffer_load_dword v250, v252, s[36:39], 0 offen sc1
    s_waitcnt lgkmcnt(8)
    v_mfma_f32_32x32x16_bf16 v[16:31], v[224:227], v[108:111], v[16:31]
    s_lshl1_add_u32 s47, s41, 2
    s_and_b32 s47, s47, 7
    s_mul_i32 s47, s47, 81920
    s_add_u32 s47, s47, s59
    s_add_u32 s49, s63, 0x23000
    s_add_u32 m0, s49, 0
    s_nop 0
    buffer_load_dwordx4 v244, s[24:27], s47 offen lds
    s_add_u32 m0, s49, 1024
    s_nop 0
    buffer_load_dwordx4 v245, s[24:27], s47 offen lds
    s_add_u32 m0, s49, 2048
    s_nop 0
    buffer_load_dwordx4 v246, s[24:27], s47 offen lds
    s_waitcnt lgkmcnt(6)
    v_mfma_f32_32x32x16_bf16 v[32:47], v[228:231], v[108:111], v[32:47]
    s_add_u32 m0, s49, 3072
    s_nop 0
    buffer_load_dwordx4 v247, s[24:27], s47 offen lds
    s_add_u32 m0, s49, 4096
    s_nop 0
    buffer_load_dwordx4 v248, s[24:27], s47 offen lds
    s_waitcnt lgkmcnt(4)
    v_mfma_f32_32x32x16_bf16 v[48:63], v[232:235], v[108:111], v[48:63]
    s_waitcnt lgkmcnt(2)
    v_mfma_f32_32x32x16_bf16 v[64:79], v[236:239], v[108:111], v[64:79]
    s_waitcnt lgkmcnt(0)
    v_mfma_f32_32x32x16_bf16 v[80:95], v[240:243], v[108:111], v[80:95]
    s_waitcnt vmcnt(14)
    s_lshl2_add_u32 s97, s41, s57
    v_mov_b32 v254, 1
    v_mov_b32 v255, 0
    s_mov_b64 exec, 1
    buffer_store_dword v254, v255, s[32:35], s97 offen offset:0 sc1
    s_mov_b64 exec, -1
    s_barrier
    ds_read_b64_tr_b16 v[224:225], v5 offset:20480
    ds_read_b64_tr_b16 v[226:227], v5 offset:21760
    ds_read_b64_tr_b16 v[228:229], v6 offset:20480
    ds_read_b64_tr_b16 v[230:231], v6 offset:21760
    ds_read_b64_tr_b16 v[232:233], v7 offset:20480
    ds_read_b64_tr_b16 v[234:235], v7 offset:21760
    ds_read_b64_tr_b16 v[236:237], v8 offset:20480
    ds_read_b64_tr_b16 v[238:239], v8 offset:21760
    ds_read_b64_tr_b16 v[240:241], v9 offset:20480
    ds_read_b64_tr_b16 v[242:243], v9 offset:21760
    s_waitcnt lgkmcnt(8)
    v_mfma_f32_32x32x16_bf16 v[16:31], v[224:227], v[112:115], v[16:31]
    ds_read_b64_tr_b16 v[224:225], v5 offset:25600
    ds_read_b64_tr_b16 v[226:227], v5 offset:26880
    s_waitcnt lgkmcnt(8)
    v_mfma_f32_32x32x16_bf16 v[32:47], v[228:231], v[112:115], v[32:47]
    ds_read_b64_tr_b16 v[228:229], v6 offset:25600
    ds_read_b64_tr_b16 v[230:231], v6 offset:26880
    s_waitcnt lgkmcnt(8)
    v_mfma_f32_32x32x16_bf16 v[48:63], v[232:235], v[112:115], v[48:63]
    ds_read_b64_tr_b16 v[232:233], v7 offset:25600
    ds_read_b64_tr_b16 v[234:235], v7 offset:26880
    s_add_u32 s46, s40, 0x214000
    s_add_u32 m0, s45, 0x8000
    s_nop 0
    buffer_load_dwordx4 v1, s[12:15], s46 offen nt lds
    s_add_u32 s46, s40, 0x215000
    s_add_u32 m0, s45, 0x9000
    s_nop 0
    buffer_load_dwordx4 v1, s[12:15], s46 offen nt lds
    s_add_u32 s46, s40, 0x216000
    s_add_u32 m0, s45, 0xa000
    s_nop 0
    buffer_load_dwordx4 v1, s[12:15], s46 offen nt lds
    s_waitcnt lgkmcnt(8)
    v_mfma_f32_32x32x16_bf16 v[64:79], v[236:239], v[112:115], v[64:79]
    ds_read_b64_tr_b16 v[236:237], v8 offset:25600
    ds_read_b64_tr_b16 v[238:239], v8 offset:26880
    s_add_u32 s46, s40, 0x217000
    s_add_u32 m0, s45, 0xb000
    s_nop 0
    buffer_load_dwordx4 v1, s[12:15], s46 offen nt lds
    s_add_u32 s46, s40, 0x210000
    s_add_u32 m0, s45, 0xc000
    s_nop 0
    buffer_load_dwordx4 v2, s[16:19], s46 offen nt lds
    s_add_u32 s46, s40, 0x211000
    s_add_u32 m0, s45, 0xd000
    s_nop 0
    buffer_load_dwordx4 v2, s[16:19], s46 offen nt lds
    s_waitcnt lgkmcnt(8)
    v_mfma_f32_32x32x16_bf16 v[80:95], v[240:243], v[112:115], v[80:95]
    ds_read_b64_tr_b16 v[240:241], v9 offset:25600
    ds_read_b64_tr_b16 v[242:243], v9 offset:26880
    s_add_u32 s46, s40, 0x212000
    s_add_u32 m0, s45, 0xe000
    s_nop 0
    buffer_load_dwordx4 v2, s[16:19], s46 offen nt lds
    s_add_u32 s46, s40, 0x213000
    s_add_u32 m0, s45, 0xf000
    s_nop 0
    buffer_load_dwordx4 v2, s[16:19], s46 offen nt lds
    s_waitcnt lgkmcnt(8)
    v_mfma_f32_32x32x16_bf16 v[16:31], v[224:227], v[116:119], v[16:31]
    s_lshl1_add_u32 s47, s41, 3
    s_and_b32 s47, s47, 7
    s_mul_i32 s47, s47, 81920
    s_add_u32 s47, s47, s59
    s_add_u32 s49, s63, 0x19000
    s_add_u32 m0, s49, 0
    s_nop 0
    buffer_load_dwordx4 v244, s[24:27], s47 offen lds
    s_add_u32 m0, s49, 1024
    s_nop 0
    buffer_load_dwordx4 v245, s[24:27], s47 offen lds
    s_add_u32 m0, s49, 2048
    s_nop 0
    buffer_load_dwordx4 v246, s[24:27], s47 offen lds
    s_waitcnt lgkmcnt(6)
    v_mfma_f32_32x32x16_bf16 v[32:47], v[228:231], v[116:119], v[32:47]
    s_add_u32 m0, s49, 3072
    s_nop 0
    buffer_load_dwordx4 v247, s[24:27], s47 offen lds
    s_add_u32 m0, s49, 4096
    s_nop 0
    buffer_load_dwordx4 v248, s[24:27], s47 offen lds
    s_waitcnt lgkmcnt(4)
    v_mfma_f32_32x32x16_bf16 v[48:63], v[232:235], v[116:119], v[48:63]
    s_waitcnt lgkmcnt(2)
    v_mfma_f32_32x32x16_bf16 v[64:79], v[236:239], v[116:119], v[64:79]
    s_waitcnt lgkmcnt(0)
    v_mfma_f32_32x32x16_bf16 v[80:95], v[240:243], v[116:119], v[80:95]
    s_waitcnt vmcnt(20)
    s_barrier
    ds_read_b64_tr_b16 v[224:225], v5 offset:30720
    ds_read_b64_tr_b16 v[226:227], v5 offset:32000
    ds_read_b64_tr_b16 v[228:229], v6 offset:30720
    ds_read_b64_tr_b16 v[230:231], v6 offset:32000
    ds_read_b64_tr_b16 v[232:233], v7 offset:30720
    ds_read_b64_tr_b16 v[234:235], v7 offset:32000
    ds_read_b64_tr_b16 v[236:237], v8 offset:30720
    ds_read_b64_tr_b16 v[238:239], v8 offset:32000
    ds_read_b64_tr_b16 v[240:241], v9 offset:30720
    ds_read_b64_tr_b16 v[242:243], v9 offset:32000
    s_waitcnt lgkmcnt(8)
    v_mfma_f32_32x32x16_bf16 v[16:31], v[224:227], v[120:123], v[16:31]
    ds_read_b64_tr_b16 v[224:225], v5 offset:35840
    ds_read_b64_tr_b16 v[226:227], v5 offset:37120
    s_waitcnt lgkmcnt(8)
    v_mfma_f32_32x32x16_bf16 v[32:47], v[228:231], v[120:123], v[32:47]
    ds_read_b64_tr_b16 v[228:229], v6 offset:35840
    ds_read_b64_tr_b16 v[230:231], v6 offset:37120
    s_waitcnt lgkmcnt(8)
    v_mfma_f32_32x32x16_bf16 v[48:63], v[232:235], v[120:123], v[48:63]
    ds_read_b64_tr_b16 v[232:233], v7 offset:35840
    ds_read_b64_tr_b16 v[234:235], v7 offset:37120
    s_add_u32 s46, s40, 0x218000
    s_add_u32 m0, s45, 0x10000
    s_nop 0
    buffer_load_dwordx4 v1, s[12:15], s46 offen nt lds
    s_add_u32 s46, s40, 0x219000
    s_add_u32 m0, s45, 0x11000
    s_nop 0
    buffer_load_dwordx4 v1, s[12:15], s46 offen nt lds
    s_waitcnt lgkmcnt(8)
    v_mfma_f32_32x32x16_bf16 v[64:79], v[236:239], v[120:123], v[64:79]
    ds_read_b64_tr_b16 v[236:237], v8 offset:35840
    ds_read_b64_tr_b16 v[238:239], v8 offset:37120
    s_add_u32 s46, s40, 0x21a000
    s_add_u32 m0, s45, 0x12000
    s_nop 0
    buffer_load_dwordx4 v1, s[12:15], s46 offen nt lds
    s_add_u32 s46, s40, 0x21b000
    s_add_u32 m0, s45, 0x13000
    s_nop 0
    buffer_load_dwordx4 v1, s[12:15], s46 offen nt lds
    s_waitcnt lgkmcnt(8)
    v_mfma_f32_32x32x16_bf16 v[80:95], v[240:243], v[120:123], v[80:95]
    ds_read_b64_tr_b16 v[240:241], v9 offset:35840
    ds_read_b64_tr_b16 v[242:243], v9 offset:37120
    s_add_u32 s46, s40, 0x214000
    s_add_u32 m0, s45, 0x14000
    s_nop 0
    buffer_load_dwordx4 v2, s[16:19], s46 offen nt lds
    s_waitcnt lgkmcnt(8)
    v_mfma_f32_32x32x16_bf16 v[16:31], v[224:227], v[124:127], v[16:31]
    s_add_u32 s46, s40, 0x215000
    s_add_u32 m0, s45, 0x15000
    s_nop 0
    buffer_load_dwordx4 v2, s[16:19], s46 offen nt lds
    s_add_u32 s46, s40, 0x216000
    s_add_u32 m0, s45, 0x16000
    s_nop 0
    buffer_load_dwordx4 v2, s[16:19], s46 offen nt lds
    s_waitcnt lgkmcnt(6)
    v_mfma_f32_32x32x16_bf16 v[32:47], v[228:231], v[124:127], v[32:47]
    s_add_u32 s46, s40, 0x217000
    s_add_u32 m0, s45, 0x17000
    s_nop 0
    buffer_load_dwordx4 v2, s[16:19], s46 offen nt lds
    s_waitcnt lgkmcnt(4)
    v_mfma_f32_32x32x16_bf16 v[48:63], v[232:235], v[124:127], v[48:63]
    s_waitcnt lgkmcnt(2)
    v_mfma_f32_32x32x16_bf16 v[64:79], v[236:239], v[124:127], v[64:79]
    s_waitcnt lgkmcnt(0)
    v_mfma_f32_32x32x16_bf16 v[80:95], v[240:243], v[124:127], v[80:95]
    s_waitcnt vmcnt(27)
    v_cmp_gt_u32 vcc, 16, v250
    s_cbranch_vccnz SPINC
SPINC_OUT:
    buffer_load_dword v249, v251, s[32:35], s57 offen sc1
    s_waitcnt vmcnt(9)
    s_barrier
    v_min_u32 v14, 39, v0
    v_lshlrev_b32 v14, 7, v14
    s_add_u32 s46, s40, 0x21c000
    s_add_u32 m0, s45, 0x0
    s_nop 0
    buffer_load_dwordx4 v1, s[12:15], s46 offen nt lds
    s_add_u32 s46, s40, 0x21d000
    s_add_u32 m0, s45, 0x1000
    s_nop 0
    buffer_load_dwordx4 v1, s[12:15], s46 offen nt lds
    s_add_u32 s46, s40, 0x21e000
    s_add_u32 m0, s45, 0x2000
    s_nop 0
    buffer_load_dwordx4 v1, s[12:15], s46 offen nt lds
    s_add_u32 s46, s40, 0x21f000
    s_add_u32 m0, s45, 0x3000
    s_nop 0
    buffer_load_dwordx4 v1, s[12:15], s46 offen nt lds
    s_add_u32 s46, s40, 0x218000
    s_add_u32 m0, s45, 0x4000
    s_nop 0
    buffer_load_dwordx4 v2, s[16:19], s46 offen nt lds
    s_add_u32 s46, s40, 0x219000
    s_add_u32 m0, s45, 0x5000
    s_nop 0
    buffer_load_dwordx4 v2, s[16:19], s46 offen nt lds
    s_add_u32 s46, s40, 0x21a000
    s_add_u32 m0, s45, 0x6000
    s_nop 0
    buffer_load_dwordx4 v2, s[16:19], s46 offen nt lds
    s_add_u32 s46, s40, 0x21b000
    s_add_u32 m0, s45, 0x7000
    s_nop 0
    buffer_load_dwordx4 v2, s[16:19], s46 offen nt lds
    s_lshl1_add_u32 s47, s41, 4
    s_and_b32 s47, s47, 7
    s_mul_i32 s47, s47, 81920
    s_add_u32 s47, s47, s59
    s_add_u32 s49, s63, 0x1e000
    s_add_u32 m0, s49, 0
    s_nop 0
    buffer_load_dwordx4 v244, s[24:27], s47 offen lds
    s_add_u32 m0, s49, 1024
    s_nop 0
    buffer_load_dwordx4 v245, s[24:27], s47 offen lds
    s_add_u32 m0, s49, 2048
    s_nop 0
    buffer_load_dwordx4 v246, s[24:27], s47 offen lds
    s_add_u32 m0, s49, 3072
    s_nop 0
    buffer_load_dwordx4 v247, s[24:27], s47 offen lds
    s_add_u32 m0, s49, 4096
    s_nop 0
    buffer_load_dwordx4 v248, s[24:27], s47 offen lds
    s_waitcnt vmcnt(13)
    v_cmp_ne_u32 vcc, 1, v249
    s_cbranch_vccnz SPINF1
SPINF1_OUT:
    s_add_u32 s48, s41, 1
    s_and_b32 s48, s48, 3
    s_lshl_b32 s48, s48, 15
    s_add_u32 s48, s48, s56
    s_add_u32 s48, s48, 0x0
    buffer_load_dwordx4 v[128:131], v13, s[32:35], s48 offen offset:0 sc1
    buffer_load_dwordx4 v[132:135], v13, s[32:35], s48 offen offset:1024 sc1
    buffer_load_dwordx4 v[136:139], v13, s[32:35], s48 offen offset:2048 sc1
    buffer_load_dwordx4 v[140:143], v13, s[32:35], s48 offen offset:3072 sc1
    s_lshr_b32 s47, s2, 3
    s_mul_i32 s47, s47, 20480
    s_add_u32 s47, s47, s59
    s_add_u32 s47, s47, s63
    s_add_u32 s47, s47, 0x280000
    buffer_load_dword v223, v14, s[24:27], s47 offen
    s_barrier
    ds_read_b64_tr_b16 v[224:225], v5 offset:40960
    ds_read_b64_tr_b16 v[226:227], v5 offset:42240
    ds_read_b64_tr_b16 v[228:229], v6 offset:40960
    ds_read_b64_tr_b16 v[230:231], v6 offset:42240
    ds_read_b64_tr_b16 v[232:233], v7 offset:40960
    ds_read_b64_tr_b16 v[234:235], v7 offset:42240
    ds_read_b64_tr_b16 v[236:237], v8 offset:40960
    ds_read_b64_tr_b16 v[238:239], v8 offset:42240
    ds_read_b64_tr_b16 v[240:241], v9 offset:40960
    ds_read_b64_tr_b16 v[242:243], v9 offset:42240
    s_waitcnt vmcnt(4) lgkmcnt(8)
    v_mfma_f32_32x32x16_bf16 v[16:31], v[224:227], v[128:131], v[16:31]
    ds_read_b64_tr_b16 v[224:225], v5 offset:46080
    ds_read_b64_tr_b16 v[226:227], v5 offset:47360
    s_waitcnt lgkmcnt(8)
    v_mfma_f32_32x32x16_bf16 v[32:47], v[228:231], v[128:131], v[32:47]
    ds_read_b64_tr_b16 v[228:229], v6 offset:46080
    ds_read_b64_tr_b16 v[230:231], v6 offset:47360
    s_waitcnt lgkmcnt(8)
    v_mfma_f32_32x32x16_bf16 v[48:63], v[232:235], v[128:131], v[48:63]
    ds_read_b64_tr_b16 v[232:233], v7 offset:46080
    ds_read_b64_tr_b16 v[234:235], v7 offset:47360
    s_add_u32 s48, s41, 1
    s_and_b32 s48, s48, 3
    s_lshl_b32 s48, s48, 15
    s_add_u32 s48, s48, s56
    s_add_u32 s48, s48, 0x1000
    buffer_load_dwordx4 v[144:147], v13, s[32:35], s48 offen offset:0 sc1
    buffer_load_dwordx4 v[148:151], v13, s[32:35], s48 offen offset:1024 sc1
    s_waitcnt lgkmcnt(8)
    v_mfma_f32_32x32x16_bf16 v[64:79], v[236:239], v[128:131], v[64:79]
    ds_read_b64_tr_b16 v[236:237], v8 offset:46080
    ds_read_b64_tr_b16 v[238:239], v8 offset:47360
    buffer_load_dwordx4 v[152:155], v13, s[32:35], s48 offen offset:2048 sc1
    s_waitcnt lgkmcnt(8)
    v_mfma_f32_32x32x16_bf16 v[80:95], v[240:243], v[128:131], v[80:95]
    ds_read_b64_tr_b16 v[240:241], v9 offset:46080
    ds_read_b64_tr_b16 v[242:243], v9 offset:47360
    buffer_load_dwordx4 v[156:159], v13, s[32:35], s48 offen offset:3072 sc1
    s_waitcnt vmcnt(7) lgkmcnt(8)
    v_mfma_f32_32x32x16_bf16 v[16:31], v[224:227], v[132:135], v[16:31]
    ds_read_b64_tr_b16 v[224:225], v5 offset:51200
    ds_read_b64_tr_b16 v[226:227], v5 offset:52480
    s_add_u32 s48, s41, 2
    s_and_b32 s48, s48, 3
    s_lshl_b32 s48, s48, 15
    s_add_u32 s48, s48, s56
    s_add_u32 s48, s48, 0x0
    buffer_load_dwordx4 v[160:163], v13, s[32:35], s48 offen offset:0 sc1
    s_waitcnt lgkmcnt(8)
    v_mfma_f32_32x32x16_bf16 v[32:47], v[228:231], v[132:135], v[32:47]
    ds_read_b64_tr_b16 v[228:229], v6 offset:51200
    ds_read_b64_tr_b16 v[230:231], v6 offset:52480
    buffer_load_dwordx4 v[164:167], v13, s[32:35], s48 offen offset:1024 sc1
    s_waitcnt lgkmcnt(8)
    v_mfma_f32_32x32x16_bf16 v[48:63], v[232:235], v[132:135], v[48:63]
    ds_read_b64_tr_b16 v[232:233], v7 offset:51200
    ds_read_b64_tr_b16 v[234:235], v7 offset:52480
    buffer_load_dwordx4 v[168:171], v13, s[32:35], s48 offen offset:2048 sc1
    s_waitcnt lgkmcnt(8)
    v_mfma_f32_32x32x16_bf16 v[64:79], v[236:239], v[132:135], v[64:79]
    ds_read_b64_tr_b16 v[236:237], v8 offset:51200
    ds_read_b64_tr_b16 v[238:239], v8 offset:52480
    buffer_load_dwordx4 v[172:175], v13, s[32:35], s48 offen offset:3072 sc1
    s_waitcnt lgkmcnt(8)
    v_mfma_f32_32x32x16_bf16 v[80:95], v[240:243], v[132:135], v[80:95]
    ds_read_b64_tr_b16 v[240:241], v9 offset:51200
    ds_read_b64_tr_b16 v[242:243], v9 offset:52480
    s_add_u32 s46, s40, 0x21c000
    s_add_u32 m0, s45, 0xc000
    s_nop 0
    buffer_load_dwordx4 v2, s[16:19], s46 offen nt lds
    s_waitcnt vmcnt(11) lgkmcnt(8)
    v_mfma_f32_32x32x16_bf16 v[16:31], v[224:227], v[136:139], v[16:31]
    ds_read_b64_tr_b16 v[224:225], v5 offset:56320
    ds_read_b64_tr_b16 v[226:227], v5 offset:57600
    s_add_u32 s46, s40, 0x21d000
    s_add_u32 m0, s45, 0xd000
    s_nop 0
    buffer_load_dwordx4 v2, s[16:19], s46 offen nt lds
    s_waitcnt lgkmcnt(8)
    v_mfma_f32_32x32x16_bf16 v[32:47], v[228:231], v[136:139], v[32:47]
    ds_read_b64_tr_b16 v[228:229], v6 offset:56320
    ds_read_b64_tr_b16 v[230:231], v6 offset:57600
    s_add_u32 s46, s40, 0x21e000
    s_add_u32 m0, s45, 0xe000
    s_nop 0
    buffer_load_dwordx4 v2, s[16:19], s46 offen nt lds
    s_waitcnt lgkmcnt(8)
    v_mfma_f32_32x32x16_bf16 v[48:63], v[232:235], v[136:139], v[48:63]
    ds_read_b64_tr_b16 v[232:233], v7 offset:56320
    ds_read_b64_tr_b16 v[234:235], v7 offset:57600
    s_add_u32 s46, s40, 0x21f000
    s_add_u32 m0, s45, 0xf000
    s_nop 0
    buffer_load_dwordx4 v2, s[16:19], s46 offen nt lds
    s_waitcnt lgkmcnt(8)
    v_mfma_f32_32x32x16_bf16 v[64:79], v[236:239], v[136:139], v[64:79]
    ds_read_b64_tr_b16 v[236:237], v8 offset:56320
    ds_read_b64_tr_b16 v[238:239], v8 offset:57600
    s_add_u32 s48, s41, 2
    s_and_b32 s48, s48, 3
    s_lshl_b32 s48, s48, 15
    s_add_u32 s48, s48, s56
    s_add_u32 s48, s48, 0x1000
    buffer_load_dwordx4 v[176:179], v13, s[32:35], s48 offen offset:0 sc1
    s_waitcnt lgkmcnt(8)
    v_mfma_f32_32x32x16_bf16 v[80:95], v[240:243], v[136:139], v[80:95]
    ds_read_b64_tr_b16 v[240:241], v9 offset:56320
    ds_read_b64_tr_b16 v[242:243], v9 offset:57600
    buffer_load_dwordx4 v[180:183], v13, s[32:35], s48 offen offset:1024 sc1
    s_waitcnt vmcnt(15) lgkmcnt(8)
    v_mfma_f32_32x32x16_bf16 v[16:31], v[224:227], v[140:143], v[16:31]
    ds_read_b64_tr_b16 v[224:225], v5 offset:0
    ds_read_b64_tr_b16 v[226:227], v5 offset:1280
    buffer_load_dwordx4 v[184:187], v13, s[32:35], s48 offen offset:2048 sc1
    s_waitcnt lgkmcnt(8)
    v_mfma_f32_32x32x16_bf16 v[32:47], v[228:231], v[140:143], v[32:47]
    ds_read_b64_tr_b16 v[228:229], v6 offset:0
    ds_read_b64_tr_b16 v[230:231], v6 offset:1280
    buffer_load_dwordx4 v[188:191], v13, s[32:35], s48 offen offset:3072 sc1
    s_waitcnt lgkmcnt(8)
    v_mfma_f32_32x32x16_bf16 v[48:63], v[232:235], v[140:143], v[48:63]
    ds_read_b64_tr_b16 v[232:233], v7 offset:0
    ds_read_b64_tr_b16 v[234:235], v7 offset:1280
    s_add_u32 s48, s41, 3
    s_and_b32 s48, s48, 3
    s_lshl_b32 s48, s48, 15
    s_add_u32 s48, s48, s56
    s_add_u32 s48, s48, 0x0
    buffer_load_dwordx4 v[192:195], v13, s[32:35], s48 offen offset:0 sc1
    s_waitcnt lgkmcnt(8)
    v_mfma_f32_32x32x16_bf16 v[64:79], v[236:239], v[140:143], v[64:79]
    ds_read_b64_tr_b16 v[236:237], v8 offset:0
    ds_read_b64_tr_b16 v[238:239], v8 offset:1280
    buffer_load_dwordx4 v[196:199], v13, s[32:35], s48 offen offset:1024 sc1
    s_waitcnt lgkmcnt(8)
    v_mfma_f32_32x32x16_bf16 v[80:95], v[240:243], v[140:143], v[80:95]
    ds_read_b64_tr_b16 v[240:241], v9 offset:0
    ds_read_b64_tr_b16 v[242:243], v9 offset:1280
    buffer_load_dwordx4 v[200:203], v13, s[32:35], s48 offen offset:2048 sc1
    s_waitcnt vmcnt(18) lgkmcnt(8)
    v_mfma_f32_32x32x16_bf16 v[16:31], v[224:227], v[144:147], v[16:31]
    ds_read_b64_tr_b16 v[224:225], v5 offset:5120
    ds_read_b64_tr_b16 v[226:227], v5 offset:6400
    buffer_load_dwordx4 v[204:207], v13, s[32:35], s48 offen offset:3072 sc1
    s_waitcnt lgkmcnt(8)
    v_mfma_f32_32x32x16_bf16 v[32:47], v[228:231], v[144:147], v[32:47]
    ds_read_b64_tr_b16 v[228:229], v6 offset:5120
    ds_read_b64_tr_b16 v[230:231], v6 offset:6400
    s_waitcnt lgkmcnt(8)
    v_mfma_f32_32x32x16_bf16 v[48:63], v[232:235], v[144:147], v[48:63]
    ds_read_b64_tr_b16 v[232:233], v7 offset:5120
    ds_read_b64_tr_b16 v[234:235], v7 offset:6400
    s_waitcnt lgkmcnt(8)
    v_mfma_f32_32x32x16_bf16 v[64:79], v[236:239], v[144:147], v[64:79]
    ds_read_b64_tr_b16 v[236:237], v8 offset:5120
    ds_read_b64_tr_b16 v[238:239], v8 offset:6400
    s_waitcnt lgkmcnt(8)
    v_mfma_f32_32x32x16_bf16 v[80:95], v[240:243], v[144:147], v[80:95]
    ds_read_b64_tr_b16 v[240:241], v9 offset:5120
    ds_read_b64_tr_b16 v[242:243], v9 offset:6400
    s_waitcnt vmcnt(18) lgkmcnt(8)
    v_mfma_f32_32x32x16_bf16 v[16:31], v[224:227], v[148:151], v[16:31]
    s_waitcnt lgkmcnt(6)
    v_mfma_f32_32x32x16_bf16 v[32:47], v[228:231], v[148:151], v[32:47]
    s_waitcnt lgkmcnt(4)
    v_mfma_f32_32x32x16_bf16 v[48:63], v[232:235], v[148:151], v[48:63]
    s_waitcnt lgkmcnt(2)
    v_mfma_f32_32x32x16_bf16 v[64:79], v[236:239], v[148:151], v[64:79]
    s_waitcnt lgkmcnt(0)
    v_mfma_f32_32x32x16_bf16 v[80:95], v[240:243], v[148:151], v[80:95]
    s_barrier
    ds_read_b64_tr_b16 v[224:225], v5 offset:10240
    ds_read_b64_tr_b16 v[226:227], v5 offset:11520
    ds_read_b64_tr_b16 v[228:229], v6 offset:10240
    ds_read_b64_tr_b16 v[230:231], v6 offset:11520
    ds_read_b64_tr_b16 v[232:233], v7 offset:10240
    ds_read_b64_tr_b16 v[234:235], v7 offset:11520
    ds_read_b64_tr_b16 v[236:237], v8 offset:10240
    ds_read_b64_tr_b16 v[238:239], v8 offset:11520
    ds_read_b64_tr_b16 v[240:241], v9 offset:10240
    ds_read_b64_tr_b16 v[242:243], v9 offset:11520
    s_waitcnt vmcnt(17) lgkmcnt(8)
    v_mfma_f32_32x32x16_bf16 v[16:31], v[224:227], v[152:155], v[16:31]
    ds_read_b64_tr_b16 v[224:225], v5 offset:15360
    ds_read_b64_tr_b16 v[226:227], v5 offset:16640
    s_waitcnt lgkmcnt(8)
    v_mfma_f32_32x32x16_bf16 v[32:47], v[228:231], v[152:155], v[32:47]
    ds_read_b64_tr_b16 v[228:229], v6 offset:15360
    ds_read_b64_tr_b16 v[230:231], v6 offset:16640
    s_waitcnt lgkmcnt(8)
    v_mfma_f32_32x32x16_bf16 v[48:63], v[232:235], v[152:155], v[48:63]
    ds_read_b64_tr_b16 v[232:233], v7 offset:15360
    ds_read_b64_tr_b16 v[234:235], v7 offset:16640
    s_lshl1_add_u32 s47, s41, 5
    s_and_b32 s47, s47, 7
    s_mul_i32 s47, s47, 81920
    s_add_u32 s47, s47, s59
    s_add_u32 s49, s63, 0x23000
    s_add_u32 m0, s49, 0
    s_nop 0
    buffer_load_dwordx4 v244, s[24:27], s47 offen lds
    s_waitcnt lgkmcnt(8)
    v_mfma_f32_32x32x16_bf16 v[64:79], v[236:239], v[152:155], v[64:79]
    ds_read_b64_tr_b16 v[236:237], v8 offset:15360
    ds_read_b64_tr_b16 v[238:239], v8 offset:16640
    s_add_u32 m0, s49, 1024
    s_nop 0
    buffer_load_dwordx4 v245, s[24:27], s47 offen lds
    s_waitcnt lgkmcnt(8)
    v_mfma_f32_32x32x16_bf16 v[80:95], v[240:243], v[152:155], v[80:95]
    ds_read_b64_tr_b16 v[240:241], v9 offset:15360
    ds_read_b64_tr_b16 v[242:243], v9 offset:16640
    s_add_u32 m0, s49, 2048
    s_nop 0
    buffer_load_dwordx4 v246, s[24:27], s47 offen lds
    s_waitcnt vmcnt(19) lgkmcnt(8)
    v_mfma_f32_32x32x16_bf16 v[16:31], v[224:227], v[156:159], v[16:31]
    ds_read_b64_tr_b16 v[224:225], v5 offset:20480
    ds_read_b64_tr_b16 v[226:227], v5 offset:21760
    s_add_u32 m0, s49, 3072
    s_nop 0
    buffer_load_dwordx4 v247, s[24:27], s47 offen lds
    s_waitcnt lgkmcnt(8)
    v_mfma_f32_32x32x16_bf16 v[32:47], v[228:231], v[156:159], v[32:47]
    ds_read_b64_tr_b16 v[228:229], v6 offset:20480
    ds_read_b64_tr_b16 v[230:231], v6 offset:21760
    s_add_u32 m0, s49, 4096
    s_nop 0
    buffer_load_dwordx4 v248, s[24:27], s47 offen lds
    s_waitcnt lgkmcnt(8)
    v_mfma_f32_32x32x16_bf16 v[48:63], v[232:235], v[156:159], v[48:63]
    ds_read_b64_tr_b16 v[232:233], v7 offset:20480
    ds_read_b64_tr_b16 v[234:235], v7 offset:21760
    s_lshl1_add_u32 s47, s41, 6
    s_and_b32 s47, s47, 7
    s_mul_i32 s47, s47, 81920
    s_add_u32 s47, s47, s59
    s_add_u32 s49, s63, 0xf000
    s_cmp_eq_u32 s4, 0
    s_cselect_b32 s49, 0xa000, s49
    s_add_u32 m0, s49, 0
    s_nop 0
    buffer_load_dwordx4 v244, s[24:27], s47 offen lds
    s_waitcnt lgkmcnt(8)
    v_mfma_f32_32x32x16_bf16 v[64:79], v[236:239], v[156:159], v[64:79]
    ds_read_b64_tr_b16 v[236:237], v8 offset:20480
    ds_read_b64_tr_b16 v[238:239], v8 offset:21760
    s_add_u32 m0, s49, 1024
    s_nop 0
    buffer_load_dwordx4 v245, s[24:27], s47 offen lds
    s_waitcnt lgkmcnt(8)
    v_mfma_f32_32x32x16_bf16 v[80:95], v[240:243], v[156:159], v[80:95]
    ds_read_b64_tr_b16 v[240:241], v9 offset:20480
    ds_read_b64_tr_b16 v[242:243], v9 offset:21760
    s_add_u32 m0, s49, 2048
    s_nop 0
    buffer_load_dwordx4 v246, s[24:27], s47 offen lds
    s_waitcnt vmcnt(23) lgkmcnt(8)
    v_mfma_f32_32x32x16_bf16 v[16:31], v[224:227], v[160:163], v[16:31]
    ds_read_b64_tr_b16 v[224:225], v5 offset:25600
    ds_read_b64_tr_b16 v[226:227], v5 offset:26880
    s_add_u32 m0, s49, 3072
    s_nop 0
    buffer_load_dwordx4 v247, s[24:27], s47 offen lds
    s_waitcnt lgkmcnt(8)
    v_mfma_f32_32x32x16_bf16 v[32:47], v[228:231], v[160:163], v[32:47]
    ds_read_b64_tr_b16 v[228:229], v6 offset:25600
    ds_read_b64_tr_b16 v[230:231], v6 offset:26880
    s_add_u32 m0, s49, 4096
    s_nop 0
    buffer_load_dwordx4 v248, s[24:27], s47 offen lds
    s_waitcnt lgkmcnt(8)
    v_mfma_f32_32x32x16_bf16 v[48:63], v[232:235], v[160:163], v[48:63]
    ds_read_b64_tr_b16 v[232:233], v7 offset:25600
    ds_read_b64_tr_b16 v[234:235], v7 offset:26880
    s_lshl1_add_u32 s47, s41, 7
    s_and_b32 s47, s47, 7
    s_mul_i32 s47, s47, 81920
    s_add_u32 s47, s47, s59
    s_add_u32 s49, s63, 0x14000
    s_add_u32 m0, s49, 0
    s_nop 0
    buffer_load_dwordx4 v244, s[24:27], s47 offen lds
    s_waitcnt lgkmcnt(8)
    v_mfma_f32_32x32x16_bf16 v[64:79], v[236:239], v[160:163], v[64:79]
    ds_read_b64_tr_b16 v[236:237], v8 offset:25600
    ds_read_b64_tr_b16 v[238:239], v8 offset:26880
    s_add_u32 m0, s49, 1024
    s_nop 0
    buffer_load_dwordx4 v245, s[24:27], s47 offen lds
    s_waitcnt lgkmcnt(8)
    v_mfma_f32_32x32x16_bf16 v[80:95], v[240:243], v[160:163], v[80:95]
    ds_read_b64_tr_b16 v[240:241], v9 offset:25600
    ds_read_b64_tr_b16 v[242:243], v9 offset:26880
    s_add_u32 m0, s49, 2048
    s_nop 0
    buffer_load_dwordx4 v246, s[24:27], s47 offen lds
    s_waitcnt vmcnt(27) lgkmcnt(8)
    v_mfma_f32_32x32x16_bf16 v[16:31], v[224:227], v[164:167], v[16:31]
    ds_read_b64_tr_b16 v[224:225], v5 offset:30720
    ds_read_b64_tr_b16 v[226:227], v5 offset:32000
    s_add_u32 m0, s49, 3072
    s_nop 0
    buffer_load_dwordx4 v247, s[24:27], s47 offen lds
    s_waitcnt lgkmcnt(8)
    v_mfma_f32_32x32x16_bf16 v[32:47], v[228:231], v[164:167], v[32:47]
    ds_read_b64_tr_b16 v[228:229], v6 offset:30720
    ds_read_b64_tr_b16 v[230:231], v6 offset:32000
    s_add_u32 m0, s49, 4096
    s_nop 0
    buffer_load_dwordx4 v248, s[24:27], s47 offen lds
    s_waitcnt lgkmcnt(8)
    v_mfma_f32_32x32x16_bf16 v[48:63], v[232:235], v[164:167], v[48:63]
    ds_read_b64_tr_b16 v[232:233], v7 offset:30720
    ds_read_b64_tr_b16 v[234:235], v7 offset:32000
    s_add_u32 s48, s41, 3
    s_and_b32 s48, s48, 3
    s_lshl_b32 s48, s48, 15
    s_add_u32 s48, s48, s56
    s_add_u32 s48, s48, 0x1000
    buffer_load_dwordx4 v[208:211], v13, s[32:35], s48 offen offset:0 sc1
    s_waitcnt lgkmcnt(8)
    v_mfma_f32_32x32x16_bf16 v[64:79], v[236:239], v[164:167], v[64:79]
    ds_read_b64_tr_b16 v[236:237], v8 offset:30720
    ds_read_b64_tr_b16 v[238:239], v8 offset:32000
    buffer_load_dwordx4 v[212:215], v13, s[32:35], s48 offen offset:1024 sc1
    s_waitcnt lgkmcnt(8)
    v_mfma_f32_32x32x16_bf16 v[80:95], v[240:243], v[164:167], v[80:95]
    ds_read_b64_tr_b16 v[240:241], v9 offset:30720
    ds_read_b64_tr_b16 v[242:243], v9 offset:32000
    buffer_load_dwordx4 v[216:219], v13, s[32:35], s48 offen offset:2048 sc1
    s_waitcnt vmcnt(31) lgkmcnt(8)
    v_mfma_f32_32x32x16_bf16 v[16:31], v[224:227], v[168:171], v[16:31]
    ds_read_b64_tr_b16 v[224:225], v5 offset:35840
    ds_read_b64_tr_b16 v[226:227], v5 offset:37120
    buffer_load_dwordx4 v[220:223], v13, s[32:35], s48 offen offset:3072 sc1
    s_waitcnt lgkmcnt(8)
    v_mfma_f32_32x32x16_bf16 v[32:47], v[228:231], v[168:171], v[32:47]
    ds_read_b64_tr_b16 v[228:229], v6 offset:35840
    ds_read_b64_tr_b16 v[230:231], v6 offset:37120
    s_waitcnt lgkmcnt(8)
    v_mfma_f32_32x32x16_bf16 v[48:63], v[232:235], v[168:171], v[48:63]
    ds_read_b64_tr_b16 v[232:233], v7 offset:35840
    ds_read_b64_tr_b16 v[234:235], v7 offset:37120
    s_waitcnt lgkmcnt(8)
    v_mfma_f32_32x32x16_bf16 v[64:79], v[236:239], v[168:171], v[64:79]
    ds_read_b64_tr_b16 v[236:237], v8 offset:35840
    ds_read_b64_tr_b16 v[238:239], v8 offset:37120
    s_waitcnt lgkmcnt(8)
    v_mfma_f32_32x32x16_bf16 v[80:95], v[240:243], v[168:171], v[80:95]
    ds_read_b64_tr_b16 v[240:241], v9 offset:35840
    ds_read_b64_tr_b16 v[242:243], v9 offset:37120
    s_waitcnt vmcnt(31) lgkmcnt(8)
    v_mfma_f32_32x32x16_bf16 v[16:31], v[224:227], v[172:175], v[16:31]
    s_waitcnt lgkmcnt(6)
    v_mfma_f32_32x32x16_bf16 v[32:47], v[228:231], v[172:175], v[32:47]
    s_waitcnt lgkmcnt(4)
    v_mfma_f32_32x32x16_bf16 v[48:63], v[232:235], v[172:175], v[48:63]
    s_waitcnt lgkmcnt(2)
    v_mfma_f32_32x32x16_bf16 v[64:79], v[236:239], v[172:175], v[64:79]
    s_waitcnt lgkmcnt(0)
    v_mfma_f32_32x32x16_bf16 v[80:95], v[240:243], v[172:175], v[80:95]
    s_waitcnt vmcnt(14)
    s_barrier
    ds_read_b64_tr_b16 v[224:225], v5 offset:40960
    ds_read_b64_tr_b16 v[226:227], v5 offset:42240
    ds_read_b64_tr_b16 v[228:229], v6 offset:40960
    ds_read_b64_tr_b16 v[230:231], v6 offset:42240
    ds_read_b64_tr_b16 v[232:233], v7 offset:40960
    ds_read_b64_tr_b16 v[234:235], v7 offset:42240
    ds_read_b64_tr_b16 v[236:237], v8 offset:40960
    ds_read_b64_tr_b16 v[238:239], v8 offset:42240
    ds_read_b64_tr_b16 v[240:241], v9 offset:40960
    ds_read_b64_tr_b16 v[242:243], v9 offset:42240
    s_waitcnt lgkmcnt(8)
    v_mfma_f32_32x32x16_bf16 v[16:31], v[224:227], v[176:179], v[16:31]
    ds_read_b64_tr_b16 v[224:225], v5 offset:46080
    ds_read_b64_tr_b16 v[226:227], v5 offset:47360
    s_waitcnt lgkmcnt(8)
    v_mfma_f32_32x32x16_bf16 v[32:47], v[228:231], v[176:179], v[32:47]
    ds_read_b64_tr_b16 v[228:229], v6 offset:46080
    ds_read_b64_tr_b16 v[230:231], v6 offset:47360
    s_waitcnt lgkmcnt(8)
    v_mfma_f32_32x32x16_bf16 v[48:63], v[232:235], v[176:179], v[48:63]
    ds_read_b64_tr_b16 v[232:233], v7 offset:46080
    ds_read_b64_tr_b16 v[234:235], v7 offset:47360
    s_lshl1_add_u32 s47, s41, 0
    s_and_b32 s47, s47, 7
    s_mul_i32 s47, s47, 81920
    s_add_u32 s47, s47, s59
    s_add_u32 s47, s47, 0x280000
    s_add_u32 s49, s63, 0x19000
    s_add_u32 m0, s49, 0
    s_nop 0
    buffer_load_dwordx4 v244, s[24:27], s47 offen lds
    s_add_u32 m0, s49, 1024
    s_nop 0
    buffer_load_dwordx4 v245, s[24:27], s47 offen lds
    s_waitcnt lgkmcnt(8)
    v_mfma_f32_32x32x16_bf16 v[64:79], v[236:239], v[176:179], v[64:79]
    ds_read_b64_tr_b16 v[236:237], v8 offset:46080
    ds_read_b64_tr_b16 v[238:239], v8 offset:47360
    s_add_u32 m0, s49, 2048
    s_nop 0
    buffer_load_dwordx4 v246, s[24:27], s47 offen lds
    s_add_u32 m0, s49, 3072
    s_nop 0
    buffer_load_dwordx4 v247, s[24:27], s47 offen lds
    s_waitcnt lgkmcnt(8)
    v_mfma_f32_32x32x16_bf16 v[80:95], v[240:243], v[176:179], v[80:95]
    ds_read_b64_tr_b16 v[240:241], v9 offset:46080
    ds_read_b64_tr_b16 v[242:243], v9 offset:47360
    s_add_u32 m0, s49, 4096
    s_nop 0
    buffer_load_dwordx4 v248, s[24:27], s47 offen lds
    s_waitcnt lgkmcnt(8)
    v_mfma_f32_32x32x16_bf16 v[16:31], v[224:227], v[180:183], v[16:31]
    ds_read_b64_tr_b16 v[224:225], v5 offset:51200
    ds_read_b64_tr_b16 v[226:227], v5 offset:52480
    s_lshl1_add_u32 s47, s41, 1
    s_and_b32 s47, s47, 7
    s_mul_i32 s47, s47, 81920
    s_add_u32 s47, s47, s59
    s_add_u32 s47, s47, 0x280000
    s_add_u32 s49, s63, 0x1e000
    s_add_u32 m0, s49, 0
    s_nop 0
    buffer_load_dwordx4 v244, s[24:27], s47 offen lds
    s_add_u32 m0, s49, 1024
    s_nop 0
    buffer_load_dwordx4 v245, s[24:27], s47 offen lds
    s_waitcnt lgkmcnt(8)
    v_mfma_f32_32x32x16_bf16 v[32:47], v[228:231], v[180:183], v[32:47]
    ds_read_b64_tr_b16 v[228:229], v6 offset:51200
    ds_read_b64_tr_b16 v[230:231], v6 offset:52480
    s_add_u32 m0, s49, 2048
    s_nop 0
    buffer_load_dwordx4 v246, s[24:27], s47 offen lds
    s_add_u32 m0, s49, 3072
    s_nop 0
    buffer_load_dwordx4 v247, s[24:27], s47 offen lds
    s_waitcnt lgkmcnt(8)
    v_mfma_f32_32x32x16_bf16 v[48:63], v[232:235], v[180:183], v[48:63]
    ds_read_b64_tr_b16 v[232:233], v7 offset:51200
    ds_read_b64_tr_b16 v[234:235], v7 offset:52480
    s_add_u32 m0, s49, 4096
    s_nop 0
    buffer_load_dwordx4 v248, s[24:27], s47 offen lds
    s_waitcnt lgkmcnt(8)
    v_mfma_f32_32x32x16_bf16 v[64:79], v[236:239], v[180:183], v[64:79]
    ds_read_b64_tr_b16 v[236:237], v8 offset:51200
    ds_read_b64_tr_b16 v[238:239], v8 offset:52480
    s_lshl1_add_u32 s47, s41, 2
    s_and_b32 s47, s47, 7
    s_mul_i32 s47, s47, 81920
    s_add_u32 s47, s47, s59
    s_add_u32 s47, s47, 0x280000
    s_add_u32 s49, s63, 0x0
    s_add_u32 m0, s49, 0
    s_nop 0
    buffer_load_dwordx4 v244, s[24:27], s47 offen lds
    s_add_u32 m0, s49, 1024
    s_nop 0
    buffer_load_dwordx4 v245, s[24:27], s47 offen lds
    s_waitcnt lgkmcnt(8)
    v_mfma_f32_32x32x16_bf16 v[80:95], v[240:243], v[180:183], v[80:95]
    ds_read_b64_tr_b16 v[240:241], v9 offset:51200
    ds_read_b64_tr_b16 v[242:243], v9 offset:52480
    s_add_u32 m0, s49, 2048
    s_nop 0
    buffer_load_dwordx4 v246, s[24:27], s47 offen lds
    s_add_u32 m0, s49, 3072
    s_nop 0
    buffer_load_dwordx4 v247, s[24:27], s47 offen lds
    s_waitcnt lgkmcnt(8)
    v_mfma_f32_32x32x16_bf16 v[16:31], v[224:227], v[184:187], v[16:31]
    ds_read_b64_tr_b16 v[224:225], v5 offset:56320
    ds_read_b64_tr_b16 v[226:227], v5 offset:57600
    s_add_u32 m0, s49, 4096
    s_nop 0
    buffer_load_dwordx4 v248, s[24:27], s47 offen lds
    s_waitcnt lgkmcnt(8)
    v_mfma_f32_32x32x16_bf16 v[32:47], v[228:231], v[184:187], v[32:47]
    ds_read_b64_tr_b16 v[228:229], v6 offset:56320
    ds_read_b64_tr_b16 v[230:231], v6 offset:57600
    s_lshl1_add_u32 s47, s41, 3
    s_and_b32 s47, s47, 7
    s_mul_i32 s47, s47, 81920
    s_add_u32 s47, s47, s59
    s_add_u32 s47, s47, 0x280000
    s_add_u32 s49, s63, 0x5000
    s_add_u32 m0, s49, 0
    s_nop 0
    buffer_load_dwordx4 v244, s[24:27], s47 offen lds
    s_add_u32 m0, s49, 1024
    s_nop 0
    buffer_load_dwordx4 v245, s[24:27], s47 offen lds
    s_waitcnt lgkmcnt(8)
    v_mfma_f32_32x32x16_bf16 v[48:63], v[232:235], v[184:187], v[48:63]
    ds_read_b64_tr_b16 v[232:233], v7 offset:56320
    ds_read_b64_tr_b16 v[234:235], v7 offset:57600
    s_add_u32 m0, s49, 2048
    s_nop 0
    buffer_load_dwordx4 v246, s[24:27], s47 offen lds
    s_add_u32 m0, s49, 3072
    s_nop 0
    buffer_load_dwordx4 v247, s[24:27], s47 offen lds
    s_waitcnt lgkmcnt(8)
    v_mfma_f32_32x32x16_bf16 v[64:79], v[236:239], v[184:187], v[64:79]
    ds_read_b64_tr_b16 v[236:237], v8 offset:56320
    ds_read_b64_tr_b16 v[238:239], v8 offset:57600
    s_add_u32 m0, s49, 4096
    s_nop 0
    buffer_load_dwordx4 v248, s[24:27], s47 offen lds
    s_waitcnt lgkmcnt(8)
    v_mfma_f32_32x32x16_bf16 v[80:95], v[240:243], v[184:187], v[80:95]
    ds_read_b64_tr_b16 v[240:241], v9 offset:56320
    ds_read_b64_tr_b16 v[242:243], v9 offset:57600
    s_waitcnt lgkmcnt(8)
    v_mfma_f32_32x32x16_bf16 v[16:31], v[224:227], v[188:191], v[16:31]
    s_waitcnt lgkmcnt(6)
    v_mfma_f32_32x32x16_bf16 v[32:47], v[228:231], v[188:191], v[32:47]
    s_waitcnt lgkmcnt(4)
    v_mfma_f32_32x32x16_bf16 v[48:63], v[232:235], v[188:191], v[48:63]
    s_waitcnt lgkmcnt(2)
    v_mfma_f32_32x32x16_bf16 v[64:79], v[236:239], v[188:191], v[64:79]
    s_waitcnt lgkmcnt(0)
    v_mfma_f32_32x32x16_bf16 v[80:95], v[240:243], v[188:191], v[80:95]
    s_add_u32 s46, s63, 0xb400
    v_add_u32 v252, s46, v13
    v_add_u32 v253, 0x17c00, v252
    s_lshl_b32 s50, s42, 12
    s_add_u32 s50, s50, s96
    s_add_u32 s98, s42, 1
    s_and_b32 s98, s98, 3
    s_lshl_b32 s98, s98, 14
    s_add_u32 s98, s98, s50
    s_add_u32 s99, s42, 2
    s_and_b32 s99, s99, 3
    s_lshl_b32 s99, s99, 14
    s_add_u32 s99, s99, s50
    s_add_u32 s100, s42, 3
    s_and_b32 s100, s100, 3
    s_lshl_b32 s100, s100, 14
    s_add_u32 s100, s100, s50
    s_lshl_b32 s101, s4, 14
    s_add_u32 s101, s101, s50
    v_and_b32 v250, 31, v0
    s_movk_i32 s46, 1280
    v_mul_lo_u32 v250, v250, s46
    v_lshrrev_b32 v14, 5, v0
    v_lshl_add_u32 v250, v14, 4, v250
    s_lshl2_add_u32 s46, s6, s4
    s_mul_i32 s52, s46, 40960
    s_mul_i32 s46, s41, 320
    s_add_u32 s52, s52, s46
    s_sub_u32 s46, s42, s4
    s_and_b32 s46, s46, 3
    s_lshl_b32 s46, s46, 6
    s_add_u32 s51, s52, s46
    s_waitcnt vmcnt(24)
    s_barrier
    v_add_u32 v5, 0xffff1000, v5
    ds_read_b64_tr_b16 v[224:225], v5 offset:0
    ds_read_b64_tr_b16 v[226:227], v5 offset:1280
    v_add_u32 v6, 0xffff1000, v6
    ds_read_b64_tr_b16 v[228:229], v6 offset:0
    ds_read_b64_tr_b16 v[230:231], v6 offset:1280
    v_add_u32 v7, 0xffff1000, v7
    ds_read_b64_tr_b16 v[232:233], v7 offset:0
    ds_read_b64_tr_b16 v[234:235], v7 offset:1280
    v_add_u32 v8, 0xffff1000, v8
    ds_read_b64_tr_b16 v[236:237], v8 offset:0
    ds_read_b64_tr_b16 v[238:239], v8 offset:1280
    v_add_u32 v9, 0xffff1000, v9
    ds_read_b64_tr_b16 v[240:241], v9 offset:0
    ds_read_b64_tr_b16 v[242:243], v9 offset:1280
    s_waitcnt lgkmcnt(8)
    v_mfma_f32_32x32x16_bf16 v[16:31], v[224:227], v[192:195], v[16:31]
    ds_read_b64_tr_b16 v[224:225], v5 offset:25600
    ds_read_b64_tr_b16 v[226:227], v5 offset:26880
    s_waitcnt lgkmcnt(8)
    v_mfma_f32_32x32x16_bf16 v[32:47], v[228:231], v[192:195], v[32:47]
    ds_read_b64_tr_b16 v[228:229], v6 offset:25600
    ds_read_b64_tr_b16 v[230:231], v6 offset:26880
    s_waitcnt lgkmcnt(8)
    v_mfma_f32_32x32x16_bf16 v[48:63], v[232:235], v[192:195], v[48:63]
    ds_read_b64_tr_b16 v[232:233], v7 offset:25600
    ds_read_b64_tr_b16 v[234:235], v7 offset:26880
    s_waitcnt lgkmcnt(8)
    v_mfma_f32_32x32x16_bf16 v[64:79], v[236:239], v[192:195], v[64:79]
    ds_read_b64_tr_b16 v[236:237], v8 offset:25600
    ds_read_b64_tr_b16 v[238:239], v8 offset:26880
    s_waitcnt lgkmcnt(8)
    v_mfma_f32_32x32x16_bf16 v[80:95], v[240:243], v[192:195], v[80:95]
    ds_read_b64_tr_b16 v[240:241], v9 offset:25600
    ds_read_b64_tr_b16 v[242:243], v9 offset:26880
    s_waitcnt lgkmcnt(8)
    v_mfma_f32_32x32x16_bf16 v[16:31], v[224:227], v[196:199], v[16:31]
    ds_read_b64_tr_b16 v[224:225], v5 offset:30720
    ds_read_b64_tr_b16 v[226:227], v5 offset:32000
    s_waitcnt lgkmcnt(8)
    v_mfma_f32_32x32x16_bf16 v[32:47], v[228:231], v[196:199], v[32:47]
    ds_read_b64_tr_b16 v[228:229], v6 offset:30720
    ds_read_b64_tr_b16 v[230:231], v6 offset:32000
    s_waitcnt lgkmcnt(8)
    v_mfma_f32_32x32x16_bf16 v[48:63], v[232:235], v[196:199], v[48:63]
    ds_read_b64_tr_b16 v[232:233], v7 offset:30720
    ds_read_b64_tr_b16 v[234:235], v7 offset:32000
    s_waitcnt lgkmcnt(8)
    v_mfma_f32_32x32x16_bf16 v[64:79], v[236:239], v[196:199], v[64:79]
    ds_read_b64_tr_b16 v[236:237], v8 offset:30720
    ds_read_b64_tr_b16 v[238:239], v8 offset:32000
    s_waitcnt lgkmcnt(8)
    v_mfma_f32_32x32x16_bf16 v[80:95], v[240:243], v[196:199], v[80:95]
    ds_read_b64_tr_b16 v[240:241], v9 offset:30720
    ds_read_b64_tr_b16 v[242:243], v9 offset:32000
    s_waitcnt lgkmcnt(8)
    v_mfma_f32_32x32x16_bf16 v[16:31], v[224:227], v[200:203], v[16:31]
    ds_read_b64_tr_b16 v[224:225], v5 offset:35840
    ds_read_b64_tr_b16 v[226:227], v5 offset:37120
    s_waitcnt lgkmcnt(8)
    v_mfma_f32_32x32x16_bf16 v[32:47], v[228:231], v[200:203], v[32:47]
    ds_read_b64_tr_b16 v[228:229], v6 offset:35840
    ds_read_b64_tr_b16 v[230:231], v6 offset:37120
    s_waitcnt lgkmcnt(8)
    v_mfma_f32_32x32x16_bf16 v[48:63], v[232:235], v[200:203], v[48:63]
    ds_read_b64_tr_b16 v[232:233], v7 offset:35840
    ds_read_b64_tr_b16 v[234:235], v7 offset:37120
    s_waitcnt lgkmcnt(8)
    v_mfma_f32_32x32x16_bf16 v[64:79], v[236:239], v[200:203], v[64:79]
    ds_read_b64_tr_b16 v[236:237], v8 offset:35840
    ds_read_b64_tr_b16 v[238:239], v8 offset:37120
    s_waitcnt lgkmcnt(8)
    v_mfma_f32_32x32x16_bf16 v[80:95], v[240:243], v[200:203], v[80:95]
    ds_read_b64_tr_b16 v[240:241], v9 offset:35840
    ds_read_b64_tr_b16 v[242:243], v9 offset:37120
    s_waitcnt vmcnt(10)
    s_barrier
    ds_read_b128 v[96:99], v252 offset:0
    ds_read_b128 v[100:103], v252 offset:1024
    ds_read_b128 v[104:107], v252 offset:2048
    ds_read_b128 v[108:111], v252 offset:3072
    ds_read_b128 v[112:115], v252 offset:4096
    ds_read_b128 v[116:119], v253 offset:0
    ds_read_b128 v[120:123], v253 offset:1024
    ds_read_b128 v[124:127], v253 offset:2048
    s_waitcnt lgkmcnt(0)
    s_barrier
    v_mfma_f32_32x32x16_bf16 v[16:31], v[224:227], v[204:207], v[16:31]
    ds_read_b64_tr_b16 v[224:225], v5 offset:40960
    ds_read_b64_tr_b16 v[226:227], v5 offset:42240
    v_mfma_f32_32x32x16_bf16 v[32:47], v[228:231], v[204:207], v[32:47]
    ds_read_b64_tr_b16 v[228:229], v6 offset:40960
    ds_read_b64_tr_b16 v[230:231], v6 offset:42240
    v_mfma_f32_32x32x16_bf16 v[48:63], v[232:235], v[204:207], v[48:63]
    ds_read_b64_tr_b16 v[232:233], v7 offset:40960
    ds_read_b64_tr_b16 v[234:235], v7 offset:42240
    v_mfma_f32_32x32x16_bf16 v[64:79], v[236:239], v[204:207], v[64:79]
    ds_read_b64_tr_b16 v[236:237], v8 offset:40960
    ds_read_b64_tr_b16 v[238:239], v8 offset:42240
    v_mfma_f32_32x32x16_bf16 v[80:95], v[240:243], v[204:207], v[80:95]
    ds_read_b64_tr_b16 v[240:241], v9 offset:40960
    ds_read_b64_tr_b16 v[242:243], v9 offset:42240
    s_waitcnt lgkmcnt(8)
    v_mfma_f32_32x32x16_bf16 v[16:31], v[224:227], v[208:211], v[16:31]
    ds_read_b64_tr_b16 v[224:225], v5 offset:46080
    ds_read_b64_tr_b16 v[226:227], v5 offset:47360
    s_waitcnt lgkmcnt(8)
    v_mfma_f32_32x32x16_bf16 v[32:47], v[228:231], v[208:211], v[32:47]
    ds_read_b64_tr_b16 v[228:229], v6 offset:46080
    ds_read_b64_tr_b16 v[230:231], v6 offset:47360
    s_waitcnt lgkmcnt(8)
    v_mfma_f32_32x32x16_bf16 v[48:63], v[232:235], v[208:211], v[48:63]
    ds_read_b64_tr_b16 v[232:233], v7 offset:46080
    ds_read_b64_tr_b16 v[234:235], v7 offset:47360
    s_waitcnt lgkmcnt(8)
    v_mfma_f32_32x32x16_bf16 v[64:79], v[236:239], v[208:211], v[64:79]
    ds_read_b64_tr_b16 v[236:237], v8 offset:46080
    ds_read_b64_tr_b16 v[238:239], v8 offset:47360
    s_waitcnt lgkmcnt(8)
    v_mfma_f32_32x32x16_bf16 v[80:95], v[240:243], v[208:211], v[80:95]
    ds_read_b64_tr_b16 v[240:241], v9 offset:46080
    ds_read_b64_tr_b16 v[242:243], v9 offset:47360
    s_waitcnt lgkmcnt(8)
    v_mfma_f32_32x32x16_bf16 v[16:31], v[224:227], v[212:215], v[16:31]
    ds_read_b64_tr_b16 v[224:225], v5 offset:51200
    ds_read_b64_tr_b16 v[226:227], v5 offset:52480
    s_waitcnt lgkmcnt(8)
    v_mfma_f32_32x32x16_bf16 v[32:47], v[228:231], v[212:215], v[32:47]
    ds_read_b64_tr_b16 v[228:229], v6 offset:51200
    ds_read_b64_tr_b16 v[230:231], v6 offset:52480
    s_waitcnt lgkmcnt(8)
    v_mfma_f32_32x32x16_bf16 v[48:63], v[232:235], v[212:215], v[48:63]
    ds_read_b64_tr_b16 v[232:233], v7 offset:51200
    ds_read_b64_tr_b16 v[234:235], v7 offset:52480
    s_waitcnt lgkmcnt(8)
    v_mfma_f32_32x32x16_bf16 v[64:79], v[236:239], v[212:215], v[64:79]
    ds_read_b64_tr_b16 v[236:237], v8 offset:51200
    ds_read_b64_tr_b16 v[238:239], v8 offset:52480
    s_waitcnt lgkmcnt(8)
    v_mfma_f32_32x32x16_bf16 v[80:95], v[240:243], v[212:215], v[80:95]
    ds_read_b64_tr_b16 v[240:241], v9 offset:51200
    ds_read_b64_tr_b16 v[242:243], v9 offset:52480
    s_waitcnt lgkmcnt(8)
    v_mfma_f32_32x32x16_bf16 v[16:31], v[224:227], v[216:219], v[16:31]
    ds_read_b64_tr_b16 v[224:225], v5 offset:56320
    ds_read_b64_tr_b16 v[226:227], v5 offset:57600
    s_waitcnt lgkmcnt(8)
    v_mfma_f32_32x32x16_bf16 v[32:47], v[228:231], v[216:219], v[32:47]
    ds_read_b64_tr_b16 v[228:229], v6 offset:56320
    ds_read_b64_tr_b16 v[230:231], v6 offset:57600
    s_waitcnt lgkmcnt(8)
    v_mfma_f32_32x32x16_bf16 v[48:63], v[232:235], v[216:219], v[48:63]
    ds_read_b64_tr_b16 v[232:233], v7 offset:56320
    ds_read_b64_tr_b16 v[234:235], v7 offset:57600
    s_waitcnt lgkmcnt(8)
    v_mfma_f32_32x32x16_bf16 v[64:79], v[236:239], v[216:219], v[64:79]
    ds_read_b64_tr_b16 v[236:237], v8 offset:56320
    ds_read_b64_tr_b16 v[238:239], v8 offset:57600
    s_waitcnt lgkmcnt(8)
    v_mfma_f32_32x32x16_bf16 v[80:95], v[240:243], v[216:219], v[80:95]
    ds_read_b64_tr_b16 v[240:241], v9 offset:56320
    ds_read_b64_tr_b16 v[242:243], v9 offset:57600
    s_waitcnt lgkmcnt(8)
    v_mfma_f32_32x32x16_bf16 v[16:31], v[224:227], v[220:223], v[16:31]
    v_add_u32 v5, 0xf000, v5
    ds_read_b64_tr_b16 v[224:225], v5 offset:0
    ds_read_b64_tr_b16 v[226:227], v5 offset:1280
    s_waitcnt lgkmcnt(8)
    v_mfma_f32_32x32x16_bf16 v[32:47], v[228:231], v[220:223], v[32:47]
    v_add_u32 v6, 0xf000, v6
    ds_read_b64_tr_b16 v[228:229], v6 offset:0
    ds_read_b64_tr_b16 v[230:231], v6 offset:1280
    s_waitcnt lgkmcnt(8)
    v_mfma_f32_32x32x16_bf16 v[48:63], v[232:235], v[220:223], v[48:63]
    v_add_u32 v7, 0xf000, v7
    ds_read_b64_tr_b16 v[232:233], v7 offset:0
    ds_read_b64_tr_b16 v[234:235], v7 offset:1280
    s_waitcnt lgkmcnt(8)
    v_mfma_f32_32x32x16_bf16 v[64:79], v[236:239], v[220:223], v[64:79]
    v_add_u32 v8, 0xf000, v8
    ds_read_b64_tr_b16 v[236:237], v8 offset:0
    ds_read_b64_tr_b16 v[238:239], v8 offset:1280
    s_waitcnt lgkmcnt(8)
    v_mfma_f32_32x32x16_bf16 v[80:95], v[240:243], v[220:223], v[80:95]
    v_add_u32 v9, 0xf000, v9
    ds_read_b64_tr_b16 v[240:241], v9 offset:0
    ds_read_b64_tr_b16 v[242:243], v9 offset:1280
    s_waitcnt lgkmcnt(8)
    v_mfma_f32_32x32x16_bf16 v[16:31], v[224:227], v[96:99], v[16:31]
    ds_read_b64_tr_b16 v[224:225], v5 offset:5120
    ds_read_b64_tr_b16 v[226:227], v5 offset:6400
    s_waitcnt lgkmcnt(8)
    v_mfma_f32_32x32x16_bf16 v[32:47], v[228:231], v[96:99], v[32:47]
    ds_read_b64_tr_b16 v[228:229], v6 offset:5120
    ds_read_b64_tr_b16 v[230:231], v6 offset:6400
    s_waitcnt lgkmcnt(8)
    v_mfma_f32_32x32x16_bf16 v[48:63], v[232:235], v[96:99], v[48:63]
    ds_read_b64_tr_b16 v[232:233], v7 offset:5120
    ds_read_b64_tr_b16 v[234:235], v7 offset:6400
    s_waitcnt lgkmcnt(8)
    v_mfma_f32_32x32x16_bf16 v[64:79], v[236:239], v[96:99], v[64:79]
    ds_read_b64_tr_b16 v[236:237], v8 offset:5120
    ds_read_b64_tr_b16 v[238:239], v8 offset:6400
    s_waitcnt lgkmcnt(8)
    v_mfma_f32_32x32x16_bf16 v[80:95], v[240:243], v[96:99], v[80:95]
    ds_read_b64_tr_b16 v[240:241], v9 offset:5120
    ds_read_b64_tr_b16 v[242:243], v9 offset:6400
    s_waitcnt lgkmcnt(8)
    v_mfma_f32_32x32x16_bf16 v[16:31], v[224:227], v[100:103], v[16:31]
    ds_read_b64_tr_b16 v[224:225], v5 offset:10240
    ds_read_b64_tr_b16 v[226:227], v5 offset:11520
    s_waitcnt lgkmcnt(8)
    v_mfma_f32_32x32x16_bf16 v[32:47], v[228:231], v[100:103], v[32:47]
    ds_read_b64_tr_b16 v[228:229], v6 offset:10240
    ds_read_b64_tr_b16 v[230:231], v6 offset:11520
    s_waitcnt lgkmcnt(8)
    v_mfma_f32_32x32x16_bf16 v[48:63], v[232:235], v[100:103], v[48:63]
    ds_read_b64_tr_b16 v[232:233], v7 offset:10240
    ds_read_b64_tr_b16 v[234:235], v7 offset:11520
    s_waitcnt lgkmcnt(8)
    v_mfma_f32_32x32x16_bf16 v[64:79], v[236:239], v[100:103], v[64:79]
    ds_read_b64_tr_b16 v[236:237], v8 offset:10240
    ds_read_b64_tr_b16 v[238:239], v8 offset:11520
    s_waitcnt lgkmcnt(8)
    v_mfma_f32_32x32x16_bf16 v[80:95], v[240:243], v[100:103], v[80:95]
    ds_read_b64_tr_b16 v[240:241], v9 offset:10240
    ds_read_b64_tr_b16 v[242:243], v9 offset:11520
    s_waitcnt lgkmcnt(8)
    v_mfma_f32_32x32x16_bf16 v[16:31], v[224:227], v[104:107], v[16:31]
    ds_read_b64_tr_b16 v[224:225], v5 offset:15360
    ds_read_b64_tr_b16 v[226:227], v5 offset:16640
    s_waitcnt lgkmcnt(8)
    v_mfma_f32_32x32x16_bf16 v[32:47], v[228:231], v[104:107], v[32:47]
    ds_read_b64_tr_b16 v[228:229], v6 offset:15360
    ds_read_b64_tr_b16 v[230:231], v6 offset:16640
    s_waitcnt lgkmcnt(8)
    v_mfma_f32_32x32x16_bf16 v[48:63], v[232:235], v[104:107], v[48:63]
    ds_read_b64_tr_b16 v[232:233], v7 offset:15360
    ds_read_b64_tr_b16 v[234:235], v7 offset:16640
    s_waitcnt lgkmcnt(8)
    v_mfma_f32_32x32x16_bf16 v[64:79], v[236:239], v[104:107], v[64:79]
    ds_read_b64_tr_b16 v[236:237], v8 offset:15360
    ds_read_b64_tr_b16 v[238:239], v8 offset:16640
    s_waitcnt lgkmcnt(8)
    v_mfma_f32_32x32x16_bf16 v[80:95], v[240:243], v[104:107], v[80:95]
    ds_read_b64_tr_b16 v[240:241], v9 offset:15360
    ds_read_b64_tr_b16 v[242:243], v9 offset:16640
    s_waitcnt lgkmcnt(8)
    v_mfma_f32_32x32x16_bf16 v[16:31], v[224:227], v[108:111], v[16:31]
    ds_read_b64_tr_b16 v[224:225], v5 offset:20480
    ds_read_b64_tr_b16 v[226:227], v5 offset:21760
    s_waitcnt lgkmcnt(8)
    v_mfma_f32_32x32x16_bf16 v[32:47], v[228:231], v[108:111], v[32:47]
    ds_read_b64_tr_b16 v[228:229], v6 offset:20480
    ds_read_b64_tr_b16 v[230:231], v6 offset:21760
    s_waitcnt lgkmcnt(8)
    v_mfma_f32_32x32x16_bf16 v[48:63], v[232:235], v[108:111], v[48:63]
    ds_read_b64_tr_b16 v[232:233], v7 offset:20480
    ds_read_b64_tr_b16 v[234:235], v7 offset:21760
    s_waitcnt lgkmcnt(8)
    v_mfma_f32_32x32x16_bf16 v[64:79], v[236:239], v[108:111], v[64:79]
    ds_read_b64_tr_b16 v[236:237], v8 offset:20480
    ds_read_b64_tr_b16 v[238:239], v8 offset:21760
    s_waitcnt lgkmcnt(8)
    v_mfma_f32_32x32x16_bf16 v[80:95], v[240:243], v[108:111], v[80:95]
    ds_read_b64_tr_b16 v[240:241], v9 offset:20480
    ds_read_b64_tr_b16 v[242:243], v9 offset:21760
    s_waitcnt lgkmcnt(8)
    v_mfma_f32_32x32x16_bf16 v[16:31], v[224:227], v[112:115], v[16:31]
    ds_read_b64_tr_b16 v[224:225], v5 offset:25600
    ds_read_b64_tr_b16 v[226:227], v5 offset:26880
    s_waitcnt vmcnt(0)
    s_barrier
    s_waitcnt lgkmcnt(8)
    v_mfma_f32_32x32x16_bf16 v[32:47], v[228:231], v[112:115], v[32:47]
    ds_read_b64_tr_b16 v[228:229], v6 offset:25600
    ds_read_b64_tr_b16 v[230:231], v6 offset:26880
    s_waitcnt lgkmcnt(8)
    v_mfma_f32_32x32x16_bf16 v[48:63], v[232:235], v[112:115], v[48:63]
    ds_read_b64_tr_b16 v[232:233], v7 offset:25600
    ds_read_b64_tr_b16 v[234:235], v7 offset:26880
    s_waitcnt lgkmcnt(8)
    v_mfma_f32_32x32x16_bf16 v[64:79], v[236:239], v[112:115], v[64:79]
    ds_read_b64_tr_b16 v[236:237], v8 offset:25600
    ds_read_b64_tr_b16 v[238:239], v8 offset:26880
    s_waitcnt lgkmcnt(8)
    v_mfma_f32_32x32x16_bf16 v[80:95], v[240:243], v[112:115], v[80:95]
    ds_read_b64_tr_b16 v[240:241], v9 offset:25600
    ds_read_b64_tr_b16 v[242:243], v9 offset:26880
    s_waitcnt lgkmcnt(8)
    v_mfma_f32_32x32x16_bf16 v[16:31], v[224:227], v[116:119], v[16:31]
    ds_read_b64_tr_b16 v[224:225], v5 offset:30720
    ds_read_b64_tr_b16 v[226:227], v5 offset:32000
    s_waitcnt lgkmcnt(8)
    v_mfma_f32_32x32x16_bf16 v[32:47], v[228:231], v[116:119], v[32:47]
    ds_read_b64_tr_b16 v[228:229], v6 offset:30720
    ds_read_b64_tr_b16 v[230:231], v6 offset:32000
    s_waitcnt lgkmcnt(8)
    v_mfma_f32_32x32x16_bf16 v[48:63], v[232:235], v[116:119], v[48:63]
    ds_read_b64_tr_b16 v[232:233], v7 offset:30720
    ds_read_b64_tr_b16 v[234:235], v7 offset:32000
    s_waitcnt lgkmcnt(8)
    v_mfma_f32_32x32x16_bf16 v[64:79], v[236:239], v[116:119], v[64:79]
    ds_read_b64_tr_b16 v[236:237], v8 offset:30720
    ds_read_b64_tr_b16 v[238:239], v8 offset:32000
    s_waitcnt lgkmcnt(8)
    v_mfma_f32_32x32x16_bf16 v[80:95], v[240:243], v[116:119], v[80:95]
    ds_read_b64_tr_b16 v[240:241], v9 offset:30720
    ds_read_b64_tr_b16 v[242:243], v9 offset:32000
    buffer_load_dword v249, v251, s[32:35], s57 offen offset:128 sc1
    s_waitcnt lgkmcnt(8)
    v_mfma_f32_32x32x16_bf16 v[16:31], v[224:227], v[120:123], v[16:31]
    ds_read_b64_tr_b16 v[224:225], v5 offset:35840
    ds_read_b64_tr_b16 v[226:227], v5 offset:37120
    s_waitcnt lgkmcnt(8)
    v_mfma_f32_32x32x16_bf16 v[32:47], v[228:231], v[120:123], v[32:47]
    ds_read_b64_tr_b16 v[228:229], v6 offset:35840
    ds_read_b64_tr_b16 v[230:231], v6 offset:37120
    s_waitcnt lgkmcnt(8)
    v_mfma_f32_32x32x16_bf16 v[48:63], v[232:235], v[120:123], v[48:63]
    ds_read_b64_tr_b16 v[232:233], v7 offset:35840
    ds_read_b64_tr_b16 v[234:235], v7 offset:37120
    s_waitcnt lgkmcnt(8)
    v_mfma_f32_32x32x16_bf16 v[64:79], v[236:239], v[120:123], v[64:79]
    ds_read_b64_tr_b16 v[236:237], v8 offset:35840
    ds_read_b64_tr_b16 v[238:239], v8 offset:37120
    s_waitcnt lgkmcnt(8)
    v_mfma_f32_32x32x16_bf16 v[80:95], v[240:243], v[120:123], v[80:95]
    ds_read_b64_tr_b16 v[240:241], v9 offset:35840
    ds_read_b64_tr_b16 v[242:243], v9 offset:37120
    s_waitcnt lgkmcnt(8)
    v_mfma_f32_32x32x16_bf16 v[16:31], v[224:227], v[124:127], v[16:31]
    v_add_u32 v5, 0xfffe7000, v5
    ds_read_b64_tr_b16 v[224:225], v5 offset:0
    ds_read_b64_tr_b16 v[226:227], v5 offset:1280
    s_waitcnt lgkmcnt(8)
    v_mfma_f32_32x32x16_bf16 v[32:47], v[228:231], v[124:127], v[32:47]
    v_add_u32 v6, 0xfffe7000, v6
    ds_read_b64_tr_b16 v[228:229], v6 offset:0
    ds_read_b64_tr_b16 v[230:231], v6 offset:1280
    s_waitcnt lgkmcnt(8)
    v_mfma_f32_32x32x16_bf16 v[48:63], v[232:235], v[124:127], v[48:63]
    v_add_u32 v7, 0xfffe7000, v7
    ds_read_b64_tr_b16 v[232:233], v7 offset:0
    ds_read_b64_tr_b16 v[234:235], v7 offset:1280
    s_waitcnt lgkmcnt(8)
    v_mfma_f32_32x32x16_bf16 v[64:79], v[236:239], v[124:127], v[64:79]
    v_add_u32 v8, 0xfffe7000, v8
    ds_read_b64_tr_b16 v[236:237], v8 offset:0
    ds_read_b64_tr_b16 v[238:239], v8 offset:1280
    s_waitcnt lgkmcnt(8)
    v_mfma_f32_32x32x16_bf16 v[80:95], v[240:243], v[124:127], v[80:95]
    v_add_u32 v9, 0xfffe7000, v9
    ds_read_b64_tr_b16 v[240:241], v9 offset:0
    ds_read_b64_tr_b16 v[242:243], v9 offset:1280
    s_waitcnt vmcnt(0)
    v_cmp_ne_u32 vcc, 1, v249
    s_cbranch_vccnz SPINF2
SPINF2_OUT:
    s_add_u32 s48, s41, 1
    s_and_b32 s48, s48, 3
    s_lshl_b32 s48, s48, 15
    s_add_u32 s48, s48, s56
    s_add_u32 s48, s48, 0x80000
    buffer_load_dwordx4 v[128:131], v13, s[32:35], s48 offen offset:0 sc1
    buffer_load_dwordx4 v[132:135], v13, s[32:35], s48 offen offset:1024 sc1
    buffer_load_dwordx4 v[136:139], v13, s[32:35], s48 offen offset:2048 sc1
    buffer_load_dwordx4 v[140:143], v13, s[32:35], s48 offen offset:3072 sc1
    s_add_u32 s48, s41, 1
    s_and_b32 s48, s48, 3
    s_lshl_b32 s48, s48, 15
    s_add_u32 s48, s48, s56
    s_add_u32 s48, s48, 0x81000
    buffer_load_dwordx4 v[144:147], v13, s[32:35], s48 offen offset:0 sc1
    buffer_load_dwordx4 v[148:151], v13, s[32:35], s48 offen offset:1024 sc1
    buffer_load_dwordx4 v[152:155], v13, s[32:35], s48 offen offset:2048 sc1
    buffer_load_dwordx4 v[156:159], v13, s[32:35], s48 offen offset:3072 sc1
    s_add_u32 s48, s41, 2
    s_and_b32 s48, s48, 3
    s_lshl_b32 s48, s48, 15
    s_add_u32 s48, s48, s56
    s_add_u32 s48, s48, 0x80000
    buffer_load_dwordx4 v[160:163], v13, s[32:35], s48 offen offset:0 sc1
    buffer_load_dwordx4 v[164:167], v13, s[32:35], s48 offen offset:1024 sc1
    buffer_load_dwordx4 v[168:171], v13, s[32:35], s48 offen offset:2048 sc1
    buffer_load_dwordx4 v[172:175], v13, s[32:35], s48 offen offset:3072 sc1
    s_waitcnt vmcnt(11) lgkmcnt(8)
    v_mfma_f32_32x32x16_bf16 v[16:31], v[224:227], v[128:131], v[16:31]
    ds_read_b64_tr_b16 v[224:225], v5 offset:5120
    ds_read_b64_tr_b16 v[226:227], v5 offset:6400
    s_add_u32 s48, s41, 2
    s_and_b32 s48, s48, 3
    s_lshl_b32 s48, s48, 15
    s_add_u32 s48, s48, s56
    s_add_u32 s48, s48, 0x81000
    buffer_load_dwordx4 v[176:179], v13, s[32:35], s48 offen offset:0 sc1
    s_waitcnt lgkmcnt(8)
    v_mfma_f32_32x32x16_bf16 v[32:47], v[228:231], v[128:131], v[32:47]
    ds_read_b64_tr_b16 v[228:229], v6 offset:5120
    ds_read_b64_tr_b16 v[230:231], v6 offset:6400
    s_waitcnt lgkmcnt(8)
    v_mfma_f32_32x32x16_bf16 v[48:63], v[232:235], v[128:131], v[48:63]
    ds_read_b64_tr_b16 v[232:233], v7 offset:5120
    ds_read_b64_tr_b16 v[234:235], v7 offset:6400
    buffer_load_dwordx4 v[180:183], v13, s[32:35], s48 offen offset:1024 sc1
    s_waitcnt lgkmcnt(8)
    v_mfma_f32_32x32x16_bf16 v[64:79], v[236:239], v[128:131], v[64:79]
    ds_read_b64_tr_b16 v[236:237], v8 offset:5120
    ds_read_b64_tr_b16 v[238:239], v8 offset:6400
    s_waitcnt lgkmcnt(8)
    v_mfma_f32_32x32x16_bf16 v[80:95], v[240:243], v[128:131], v[80:95]
    ds_read_b64_tr_b16 v[240:241], v9 offset:5120
    ds_read_b64_tr_b16 v[242:243], v9 offset:6400
    s_waitcnt vmcnt(12) lgkmcnt(8)
    v_mfma_f32_32x32x16_bf16 v[16:31], v[224:227], v[132:135], v[16:31]
    ds_read_b64_tr_b16 v[224:225], v5 offset:10240
    ds_read_b64_tr_b16 v[226:227], v5 offset:11520
    buffer_load_dwordx4 v[184:187], v13, s[32:35], s48 offen offset:2048 sc1
    s_waitcnt lgkmcnt(8)
    v_mfma_f32_32x32x16_bf16 v[32:47], v[228:231], v[132:135], v[32:47]
    ds_read_b64_tr_b16 v[228:229], v6 offset:10240
    ds_read_b64_tr_b16 v[230:231], v6 offset:11520
    s_waitcnt lgkmcnt(8)
    v_mfma_f32_32x32x16_bf16 v[48:63], v[232:235], v[132:135], v[48:63]
    ds_read_b64_tr_b16 v[232:233], v7 offset:10240
    ds_read_b64_tr_b16 v[234:235], v7 offset:11520
    buffer_load_dwordx4 v[188:191], v13, s[32:35], s48 offen offset:3072 sc1
    s_waitcnt lgkmcnt(8)
    v_mfma_f32_32x32x16_bf16 v[64:79], v[236:239], v[132:135], v[64:79]
    ds_read_b64_tr_b16 v[236:237], v8 offset:10240
    ds_read_b64_tr_b16 v[238:239], v8 offset:11520
    s_waitcnt lgkmcnt(8)
    v_mfma_f32_32x32x16_bf16 v[80:95], v[240:243], v[132:135], v[80:95]
    ds_read_b64_tr_b16 v[240:241], v9 offset:10240
    ds_read_b64_tr_b16 v[242:243], v9 offset:11520
    s_waitcnt vmcnt(13) lgkmcnt(8)
    v_mfma_f32_32x32x16_bf16 v[16:31], v[224:227], v[136:139], v[16:31]
    ds_read_b64_tr_b16 v[224:225], v5 offset:15360
    ds_read_b64_tr_b16 v[226:227], v5 offset:16640
    s_add_u32 s48, s41, 3
    s_and_b32 s48, s48, 3
    s_lshl_b32 s48, s48, 15
    s_add_u32 s48, s48, s56
    s_add_u32 s48, s48, 0x80000
    buffer_load_dwordx4 v[192:195], v13, s[32:35], s48 offen offset:0 sc1
    s_waitcnt lgkmcnt(8)
    v_mfma_f32_32x32x16_bf16 v[32:47], v[228:231], v[136:139], v[32:47]
    ds_read_b64_tr_b16 v[228:229], v6 offset:15360
    ds_read_b64_tr_b16 v[230:231], v6 offset:16640
    s_waitcnt lgkmcnt(8)
    v_mfma_f32_32x32x16_bf16 v[48:63], v[232:235], v[136:139], v[48:63]
    ds_read_b64_tr_b16 v[232:233], v7 offset:15360
    ds_read_b64_tr_b16 v[234:235], v7 offset:16640
    buffer_load_dwordx4 v[196:199], v13, s[32:35], s48 offen offset:1024 sc1
    s_waitcnt lgkmcnt(8)
    v_mfma_f32_32x32x16_bf16 v[64:79], v[236:239], v[136:139], v[64:79]
    ds_read_b64_tr_b16 v[236:237], v8 offset:15360
    ds_read_b64_tr_b16 v[238:239], v8 offset:16640
    s_waitcnt lgkmcnt(8)
    v_mfma_f32_32x32x16_bf16 v[80:95], v[240:243], v[136:139], v[80:95]
    ds_read_b64_tr_b16 v[240:241], v9 offset:15360
    ds_read_b64_tr_b16 v[242:243], v9 offset:16640
    s_waitcnt vmcnt(14) lgkmcnt(8)
    v_mfma_f32_32x32x16_bf16 v[16:31], v[224:227], v[140:143], v[16:31]
    ds_read_b64_tr_b16 v[224:225], v5 offset:20480
    ds_read_b64_tr_b16 v[226:227], v5 offset:21760
    buffer_load_dwordx4 v[200:203], v13, s[32:35], s48 offen offset:2048 sc1
    s_waitcnt lgkmcnt(8)
    v_mfma_f32_32x32x16_bf16 v[32:47], v[228:231], v[140:143], v[32:47]
    ds_read_b64_tr_b16 v[228:229], v6 offset:20480
    ds_read_b64_tr_b16 v[230:231], v6 offset:21760
    s_waitcnt lgkmcnt(8)
    v_mfma_f32_32x32x16_bf16 v[48:63], v[232:235], v[140:143], v[48:63]
    ds_read_b64_tr_b16 v[232:233], v7 offset:20480
    ds_read_b64_tr_b16 v[234:235], v7 offset:21760
    buffer_load_dwordx4 v[204:207], v13, s[32:35], s48 offen offset:3072 sc1
    s_waitcnt lgkmcnt(8)
    v_mfma_f32_32x32x16_bf16 v[64:79], v[236:239], v[140:143], v[64:79]
    ds_read_b64_tr_b16 v[236:237], v8 offset:20480
    ds_read_b64_tr_b16 v[238:239], v8 offset:21760
    s_waitcnt lgkmcnt(8)
    v_mfma_f32_32x32x16_bf16 v[80:95], v[240:243], v[140:143], v[80:95]
    ds_read_b64_tr_b16 v[240:241], v9 offset:20480
    ds_read_b64_tr_b16 v[242:243], v9 offset:21760
    s_waitcnt vmcnt(15) lgkmcnt(8)
    v_mfma_f32_32x32x16_bf16 v[16:31], v[224:227], v[144:147], v[16:31]
    ds_read_b64_tr_b16 v[224:225], v5 offset:25600
    ds_read_b64_tr_b16 v[226:227], v5 offset:26880
    s_add_u32 s48, s41, 3
    s_and_b32 s48, s48, 3
    s_lshl_b32 s48, s48, 15
    s_add_u32 s48, s48, s56
    s_add_u32 s48, s48, 0x81000
    buffer_load_dwordx4 v[208:211], v13, s[32:35], s48 offen offset:0 sc1
    s_waitcnt lgkmcnt(8)
    v_mfma_f32_32x32x16_bf16 v[32:47], v[228:231], v[144:147], v[32:47]
    ds_read_b64_tr_b16 v[228:229], v6 offset:25600
    ds_read_b64_tr_b16 v[230:231], v6 offset:26880
    s_waitcnt lgkmcnt(8)
    v_mfma_f32_32x32x16_bf16 v[48:63], v[232:235], v[144:147], v[48:63]
    ds_read_b64_tr_b16 v[232:233], v7 offset:25600
    ds_read_b64_tr_b16 v[234:235], v7 offset:26880
    buffer_load_dwordx4 v[212:215], v13, s[32:35], s48 offen offset:1024 sc1
    s_waitcnt lgkmcnt(8)
    v_mfma_f32_32x32x16_bf16 v[64:79], v[236:239], v[144:147], v[64:79]
    ds_read_b64_tr_b16 v[236:237], v8 offset:25600
    ds_read_b64_tr_b16 v[238:239], v8 offset:26880
    s_waitcnt lgkmcnt(8)
    v_mfma_f32_32x32x16_bf16 v[80:95], v[240:243], v[144:147], v[80:95]
    ds_read_b64_tr_b16 v[240:241], v9 offset:25600
    ds_read_b64_tr_b16 v[242:243], v9 offset:26880
    s_waitcnt vmcnt(16) lgkmcnt(8)
    v_mfma_f32_32x32x16_bf16 v[16:31], v[224:227], v[148:151], v[16:31]
    ds_read_b64_tr_b16 v[224:225], v5 offset:30720
    ds_read_b64_tr_b16 v[226:227], v5 offset:32000
    buffer_load_dwordx4 v[216:219], v13, s[32:35], s48 offen offset:2048 sc1
    s_waitcnt lgkmcnt(8)
    v_mfma_f32_32x32x16_bf16 v[32:47], v[228:231], v[148:151], v[32:47]
    ds_read_b64_tr_b16 v[228:229], v6 offset:30720
    ds_read_b64_tr_b16 v[230:231], v6 offset:32000
    s_waitcnt lgkmcnt(8)
    v_mfma_f32_32x32x16_bf16 v[48:63], v[232:235], v[148:151], v[48:63]
    ds_read_b64_tr_b16 v[232:233], v7 offset:30720
    ds_read_b64_tr_b16 v[234:235], v7 offset:32000
    buffer_load_dwordx4 v[220:223], v13, s[32:35], s48 offen offset:3072 sc1
    s_waitcnt lgkmcnt(8)
    v_mfma_f32_32x32x16_bf16 v[64:79], v[236:239], v[148:151], v[64:79]
    ds_read_b64_tr_b16 v[236:237], v8 offset:30720
    ds_read_b64_tr_b16 v[238:239], v8 offset:32000
    s_waitcnt lgkmcnt(8)
    v_mfma_f32_32x32x16_bf16 v[80:95], v[240:243], v[148:151], v[80:95]
    ds_read_b64_tr_b16 v[240:241], v9 offset:30720
    ds_read_b64_tr_b16 v[242:243], v9 offset:32000
    s_waitcnt vmcnt(17) lgkmcnt(8)
    v_mfma_f32_32x32x16_bf16 v[16:31], v[224:227], v[152:155], v[16:31]
    ds_read_b64_tr_b16 v[224:225], v5 offset:35840
    ds_read_b64_tr_b16 v[226:227], v5 offset:37120
    s_waitcnt lgkmcnt(8)
    v_mfma_f32_32x32x16_bf16 v[32:47], v[228:231], v[152:155], v[32:47]
    ds_read_b64_tr_b16 v[228:229], v6 offset:35840
    ds_read_b64_tr_b16 v[230:231], v6 offset:37120
    s_waitcnt lgkmcnt(8)
    v_mfma_f32_32x32x16_bf16 v[48:63], v[232:235], v[152:155], v[48:63]
    ds_read_b64_tr_b16 v[232:233], v7 offset:35840
    ds_read_b64_tr_b16 v[234:235], v7 offset:37120
    s_waitcnt lgkmcnt(8)
    v_mfma_f32_32x32x16_bf16 v[64:79], v[236:239], v[152:155], v[64:79]
    ds_read_b64_tr_b16 v[236:237], v8 offset:35840
    ds_read_b64_tr_b16 v[238:239], v8 offset:37120
    s_waitcnt lgkmcnt(8)
    v_mfma_f32_32x32x16_bf16 v[80:95], v[240:243], v[152:155], v[80:95]
    ds_read_b64_tr_b16 v[240:241], v9 offset:35840
    ds_read_b64_tr_b16 v[242:243], v9 offset:37120
    s_barrier
    s_waitcnt vmcnt(16) lgkmcnt(8)
    v_mfma_f32_32x32x16_bf16 v[16:31], v[224:227], v[156:159], v[16:31]
    ds_read_b64_tr_b16 v[224:225], v6 offset:46080
    ds_read_b64_tr_b16 v[226:227], v6 offset:47360
    s_waitcnt lgkmcnt(8)
    v_mfma_f32_32x32x16_bf16 v[32:47], v[228:231], v[156:159], v[32:47]
    ds_read_b64_tr_b16 v[228:229], v6 offset:51200
    ds_read_b64_tr_b16 v[230:231], v6 offset:52480
    s_waitcnt lgkmcnt(8)
    v_mfma_f32_32x32x16_bf16 v[48:63], v[232:235], v[156:159], v[48:63]
    ds_read_b64_tr_b16 v[232:233], v6 offset:56320
    ds_read_b64_tr_b16 v[234:235], v6 offset:57600
    s_waitcnt lgkmcnt(8)
    v_mfma_f32_32x32x16_bf16 v[64:79], v[236:239], v[156:159], v[64:79]
    v_add_u32 v6, 0xa000, v6
    ds_read_b64_tr_b16 v[236:237], v6 offset:20480
    ds_read_b64_tr_b16 v[238:239], v6 offset:21760
    s_waitcnt lgkmcnt(8)
    v_mfma_f32_32x32x16_bf16 v[80:95], v[240:243], v[156:159], v[80:95]
    v_add_u32 v6, 0xf000, v6
    ds_read_b64_tr_b16 v[240:241], v6 offset:40960
    ds_read_b64_tr_b16 v[242:243], v6 offset:42240
    s_waitcnt vmcnt(15) lgkmcnt(8)
    v_mfma_f32_32x32x16_bf16 v[32:47], v[224:227], v[160:163], v[32:47]
    ds_read_b64_tr_b16 v[224:225], v6 offset:46080
    ds_read_b64_tr_b16 v[226:227], v6 offset:47360
    s_waitcnt vmcnt(14) lgkmcnt(8)
    v_mfma_f32_32x32x16_bf16 v[32:47], v[228:231], v[164:167], v[32:47]
    ds_read_b64_tr_b16 v[228:229], v6 offset:51200
    ds_read_b64_tr_b16 v[230:231], v6 offset:52480
    s_waitcnt vmcnt(13) lgkmcnt(8)
    v_mfma_f32_32x32x16_bf16 v[32:47], v[232:235], v[168:171], v[32:47]
    ds_read_b64_tr_b16 v[232:233], v6 offset:56320
    ds_read_b64_tr_b16 v[234:235], v6 offset:57600
    s_waitcnt vmcnt(12) lgkmcnt(8)
    v_mfma_f32_32x32x16_bf16 v[32:47], v[236:239], v[172:175], v[32:47]
    v_add_u32 v6, 0xffff1000, v6
    ds_read_b64_tr_b16 v[236:237], v6 offset:0
    ds_read_b64_tr_b16 v[238:239], v6 offset:1280
    s_waitcnt vmcnt(11) lgkmcnt(8)
    v_mfma_f32_32x32x16_bf16 v[32:47], v[240:243], v[176:179], v[32:47]
    ds_read_b64_tr_b16 v[240:241], v6 offset:25600
    ds_read_b64_tr_b16 v[242:243], v6 offset:26880
    s_waitcnt vmcnt(10) lgkmcnt(8)
    v_mfma_f32_32x32x16_bf16 v[32:47], v[224:227], v[180:183], v[32:47]
    ds_read_b64_tr_b16 v[224:225], v6 offset:30720
    ds_read_b64_tr_b16 v[226:227], v6 offset:32000
    s_waitcnt vmcnt(9) lgkmcnt(8)
    v_mfma_f32_32x32x16_bf16 v[32:47], v[228:231], v[184:187], v[32:47]
    ds_read_b64_tr_b16 v[228:229], v6 offset:35840
    ds_read_b64_tr_b16 v[230:231], v6 offset:37120
    s_waitcnt vmcnt(8) lgkmcnt(8)
    v_mfma_f32_32x32x16_bf16 v[32:47], v[232:235], v[188:191], v[32:47]
    ds_read_b64_tr_b16 v[232:233], v6 offset:40960
    ds_read_b64_tr_b16 v[234:235], v6 offset:42240
    s_waitcnt vmcnt(7) lgkmcnt(8)
    v_mfma_f32_32x32x16_bf16 v[32:47], v[236:239], v[192:195], v[32:47]
    ds_read_b64_tr_b16 v[236:237], v6 offset:46080
    ds_read_b64_tr_b16 v[238:239], v6 offset:47360
    s_waitcnt vmcnt(6) lgkmcnt(8)
    v_mfma_f32_32x32x16_bf16 v[32:47], v[240:243], v[196:199], v[32:47]
    ds_read_b64_tr_b16 v[240:241], v6 offset:51200
    ds_read_b64_tr_b16 v[242:243], v6 offset:52480
    s_waitcnt vmcnt(5) lgkmcnt(8)
    v_mfma_f32_32x32x16_bf16 v[32:47], v[224:227], v[200:203], v[32:47]
    ds_read_b64_tr_b16 v[224:225], v6 offset:56320
    ds_read_b64_tr_b16 v[226:227], v6 offset:57600
    s_waitcnt vmcnt(4) lgkmcnt(8)
    v_mfma_f32_32x32x16_bf16 v[32:47], v[228:231], v[204:207], v[32:47]
    ds_read_b64_tr_b16 v[228:229], v7 offset:46080
    ds_read_b64_tr_b16 v[230:231], v7 offset:47360
    s_waitcnt vmcnt(3) lgkmcnt(8)
    v_mfma_f32_32x32x16_bf16 v[32:47], v[232:235], v[208:211], v[32:47]
    ds_read_b64_tr_b16 v[232:233], v7 offset:51200
    ds_read_b64_tr_b16 v[234:235], v7 offset:52480
    s_waitcnt vmcnt(2) lgkmcnt(8)
    v_mfma_f32_32x32x16_bf16 v[32:47], v[236:239], v[212:215], v[32:47]
    ds_read_b64_tr_b16 v[236:237], v7 offset:56320
    ds_read_b64_tr_b16 v[238:239], v7 offset:57600
    s_waitcnt vmcnt(1) lgkmcnt(8)
    v_mfma_f32_32x32x16_bf16 v[32:47], v[240:243], v[216:219], v[32:47]
    v_add_u32 v7, 0xa000, v7
    ds_read_b64_tr_b16 v[240:241], v7 offset:20480
    ds_read_b64_tr_b16 v[242:243], v7 offset:21760
    s_waitcnt vmcnt(0) lgkmcnt(8)
    v_mfma_f32_32x32x16_bf16 v[32:47], v[224:227], v[220:223], v[32:47]
    v_add_u32 v7, 0xf000, v7
    ds_read_b64_tr_b16 v[224:225], v7 offset:40960
    ds_read_b64_tr_b16 v[226:227], v7 offset:42240
    s_waitcnt lgkmcnt(8)
    v_mfma_f32_32x32x16_bf16 v[48:63], v[228:231], v[160:163], v[48:63]
    ds_read_b64_tr_b16 v[228:229], v7 offset:46080
    ds_read_b64_tr_b16 v[230:231], v7 offset:47360
    s_waitcnt lgkmcnt(8)
    v_mfma_f32_32x32x16_bf16 v[48:63], v[232:235], v[164:167], v[48:63]
    ds_read_b64_tr_b16 v[232:233], v7 offset:51200
    ds_read_b64_tr_b16 v[234:235], v7 offset:52480
    s_nop 0
    v_cvt_pk_bf16_f32 v96, v32, v33
    v_cvt_pk_bf16_f32 v97, v34, v35
    v_cvt_pk_bf16_f32 v98, v36, v37
    s_waitcnt lgkmcnt(8)
    v_mfma_f32_32x32x16_bf16 v[48:63], v[236:239], v[168:171], v[48:63]
    ds_read_b64_tr_b16 v[236:237], v7 offset:56320
    ds_read_b64_tr_b16 v[238:239], v7 offset:57600
    v_cvt_pk_bf16_f32 v99, v38, v39
    buffer_store_dwordx4 v[96:99], v13, s[32:35], s98 offen offset:0 sc1
    v_cvt_pk_bf16_f32 v100, v40, v41
    s_waitcnt lgkmcnt(8)
    v_mfma_f32_32x32x16_bf16 v[48:63], v[240:243], v[172:175], v[48:63]
    v_add_u32 v7, 0xffff1000, v7
    ds_read_b64_tr_b16 v[240:241], v7 offset:0
    ds_read_b64_tr_b16 v[242:243], v7 offset:1280
    v_cvt_pk_bf16_f32 v101, v42, v43
    v_cvt_pk_bf16_f32 v102, v44, v45
    v_cvt_pk_bf16_f32 v103, v46, v47
    s_waitcnt lgkmcnt(8)
    v_mfma_f32_32x32x16_bf16 v[48:63], v[224:227], v[176:179], v[48:63]
    ds_read_b64_tr_b16 v[224:225], v7 offset:25600
    ds_read_b64_tr_b16 v[226:227], v7 offset:26880
    buffer_store_dwordx4 v[100:103], v13, s[32:35], s98 offen offset:1024 sc1
    s_waitcnt lgkmcnt(8)
    v_mfma_f32_32x32x16_bf16 v[48:63], v[228:231], v[180:183], v[48:63]
    ds_read_b64_tr_b16 v[228:229], v7 offset:30720
    ds_read_b64_tr_b16 v[230:231], v7 offset:32000
    s_waitcnt lgkmcnt(8)
    v_mfma_f32_32x32x16_bf16 v[48:63], v[232:235], v[184:187], v[48:63]
    ds_read_b64_tr_b16 v[232:233], v7 offset:35840
    ds_read_b64_tr_b16 v[234:235], v7 offset:37120
    s_waitcnt lgkmcnt(8)
    v_mfma_f32_32x32x16_bf16 v[48:63], v[236:239], v[188:191], v[48:63]
    ds_read_b64_tr_b16 v[236:237], v7 offset:40960
    ds_read_b64_tr_b16 v[238:239], v7 offset:42240
    s_waitcnt lgkmcnt(8)
    v_mfma_f32_32x32x16_bf16 v[48:63], v[240:243], v[192:195], v[48:63]
    ds_read_b64_tr_b16 v[240:241], v7 offset:46080
    ds_read_b64_tr_b16 v[242:243], v7 offset:47360
    s_waitcnt lgkmcnt(8)
    v_mfma_f32_32x32x16_bf16 v[48:63], v[224:227], v[196:199], v[48:63]
    ds_read_b64_tr_b16 v[224:225], v7 offset:51200
    ds_read_b64_tr_b16 v[226:227], v7 offset:52480
    s_waitcnt lgkmcnt(8)
    v_mfma_f32_32x32x16_bf16 v[48:63], v[228:231], v[200:203], v[48:63]
    ds_read_b64_tr_b16 v[228:229], v7 offset:56320
    ds_read_b64_tr_b16 v[230:231], v7 offset:57600
    s_waitcnt lgkmcnt(8)
    v_mfma_f32_32x32x16_bf16 v[48:63], v[232:235], v[204:207], v[48:63]
    ds_read_b64_tr_b16 v[232:233], v8 offset:46080
    ds_read_b64_tr_b16 v[234:235], v8 offset:47360
    s_waitcnt lgkmcnt(8)
    v_mfma_f32_32x32x16_bf16 v[48:63], v[236:239], v[208:211], v[48:63]
    ds_read_b64_tr_b16 v[236:237], v8 offset:51200
    ds_read_b64_tr_b16 v[238:239], v8 offset:52480
    s_waitcnt lgkmcnt(8)
    v_mfma_f32_32x32x16_bf16 v[48:63], v[240:243], v[212:215], v[48:63]
    ds_read_b64_tr_b16 v[240:241], v8 offset:56320
    ds_read_b64_tr_b16 v[242:243], v8 offset:57600
    s_waitcnt lgkmcnt(8)
    v_mfma_f32_32x32x16_bf16 v[48:63], v[224:227], v[216:219], v[48:63]
    v_add_u32 v8, 0xa000, v8
    ds_read_b64_tr_b16 v[224:225], v8 offset:20480
    ds_read_b64_tr_b16 v[226:227], v8 offset:21760
    s_waitcnt lgkmcnt(8)
    v_mfma_f32_32x32x16_bf16 v[48:63], v[228:231], v[220:223], v[48:63]
    v_add_u32 v8, 0xf000, v8
    ds_read_b64_tr_b16 v[228:229], v8 offset:40960
    ds_read_b64_tr_b16 v[230:231], v8 offset:42240
    s_waitcnt lgkmcnt(8)
    v_mfma_f32_32x32x16_bf16 v[64:79], v[232:235], v[160:163], v[64:79]
    ds_read_b64_tr_b16 v[232:233], v8 offset:46080
    ds_read_b64_tr_b16 v[234:235], v8 offset:47360
    s_waitcnt lgkmcnt(8)
    v_mfma_f32_32x32x16_bf16 v[64:79], v[236:239], v[164:167], v[64:79]
    ds_read_b64_tr_b16 v[236:237], v8 offset:51200
    ds_read_b64_tr_b16 v[238:239], v8 offset:52480
    s_nop 0
    v_cvt_pk_bf16_f32 v104, v48, v49
    v_cvt_pk_bf16_f32 v105, v50, v51
    v_cvt_pk_bf16_f32 v106, v52, v53
    s_waitcnt lgkmcnt(8)
    v_mfma_f32_32x32x16_bf16 v[64:79], v[240:243], v[168:171], v[64:79]
    ds_read_b64_tr_b16 v[240:241], v8 offset:56320
    ds_read_b64_tr_b16 v[242:243], v8 offset:57600
    v_cvt_pk_bf16_f32 v107, v54, v55
    buffer_store_dwordx4 v[104:107], v13, s[32:35], s99 offen offset:0 sc1
    v_cvt_pk_bf16_f32 v108, v56, v57
    s_waitcnt lgkmcnt(8)
    v_mfma_f32_32x32x16_bf16 v[64:79], v[224:227], v[172:175], v[64:79]
    v_add_u32 v8, 0xffff1000, v8
    ds_read_b64_tr_b16 v[224:225], v8 offset:0
    ds_read_b64_tr_b16 v[226:227], v8 offset:1280
    v_cvt_pk_bf16_f32 v109, v58, v59
    v_cvt_pk_bf16_f32 v110, v60, v61
    v_cvt_pk_bf16_f32 v111, v62, v63
    s_waitcnt lgkmcnt(8)
    v_mfma_f32_32x32x16_bf16 v[64:79], v[228:231], v[176:179], v[64:79]
    ds_read_b64_tr_b16 v[228:229], v8 offset:25600
    ds_read_b64_tr_b16 v[230:231], v8 offset:26880
    buffer_store_dwordx4 v[108:111], v13, s[32:35], s99 offen offset:1024 sc1
    s_waitcnt lgkmcnt(8)
    v_mfma_f32_32x32x16_bf16 v[64:79], v[232:235], v[180:183], v[64:79]
    ds_read_b64_tr_b16 v[232:233], v8 offset:30720
    ds_read_b64_tr_b16 v[234:235], v8 offset:32000
    s_waitcnt lgkmcnt(8)
    v_mfma_f32_32x32x16_bf16 v[64:79], v[236:239], v[184:187], v[64:79]
    ds_read_b64_tr_b16 v[236:237], v8 offset:35840
    ds_read_b64_tr_b16 v[238:239], v8 offset:37120
    s_waitcnt lgkmcnt(8)
    v_mfma_f32_32x32x16_bf16 v[64:79], v[240:243], v[188:191], v[64:79]
    ds_read_b64_tr_b16 v[240:241], v8 offset:40960
    ds_read_b64_tr_b16 v[242:243], v8 offset:42240
    s_waitcnt lgkmcnt(8)
    v_mfma_f32_32x32x16_bf16 v[64:79], v[224:227], v[192:195], v[64:79]
    ds_read_b64_tr_b16 v[224:225], v8 offset:46080
    ds_read_b64_tr_b16 v[226:227], v8 offset:47360
    s_waitcnt lgkmcnt(8)
    v_mfma_f32_32x32x16_bf16 v[64:79], v[228:231], v[196:199], v[64:79]
    ds_read_b64_tr_b16 v[228:229], v8 offset:51200
    ds_read_b64_tr_b16 v[230:231], v8 offset:52480
    s_waitcnt lgkmcnt(8)
    v_mfma_f32_32x32x16_bf16 v[64:79], v[232:235], v[200:203], v[64:79]
    ds_read_b64_tr_b16 v[232:233], v8 offset:56320
    ds_read_b64_tr_b16 v[234:235], v8 offset:57600
    s_waitcnt lgkmcnt(8)
    v_mfma_f32_32x32x16_bf16 v[64:79], v[236:239], v[204:207], v[64:79]
    ds_read_b64_tr_b16 v[236:237], v9 offset:46080
    ds_read_b64_tr_b16 v[238:239], v9 offset:47360
    s_waitcnt lgkmcnt(8)
    v_mfma_f32_32x32x16_bf16 v[64:79], v[240:243], v[208:211], v[64:79]
    ds_read_b64_tr_b16 v[240:241], v9 offset:51200
    ds_read_b64_tr_b16 v[242:243], v9 offset:52480
    s_waitcnt lgkmcnt(8)
    v_mfma_f32_32x32x16_bf16 v[64:79], v[224:227], v[212:215], v[64:79]
    ds_read_b64_tr_b16 v[224:225], v9 offset:56320
    ds_read_b64_tr_b16 v[226:227], v9 offset:57600
    s_waitcnt lgkmcnt(8)
    v_mfma_f32_32x32x16_bf16 v[64:79], v[228:231], v[216:219], v[64:79]
    v_add_u32 v9, 0xa000, v9
    ds_read_b64_tr_b16 v[228:229], v9 offset:20480
    ds_read_b64_tr_b16 v[230:231], v9 offset:21760
    s_waitcnt lgkmcnt(8)
    v_mfma_f32_32x32x16_bf16 v[64:79], v[232:235], v[220:223], v[64:79]
    v_add_u32 v9, 0xf000, v9
    ds_read_b64_tr_b16 v[232:233], v9 offset:40960
    ds_read_b64_tr_b16 v[234:235], v9 offset:42240
    s_waitcnt lgkmcnt(8)
    v_mfma_f32_32x32x16_bf16 v[80:95], v[236:239], v[160:163], v[80:95]
    ds_read_b64_tr_b16 v[236:237], v9 offset:46080
    ds_read_b64_tr_b16 v[238:239], v9 offset:47360
    s_waitcnt lgkmcnt(8)
    v_mfma_f32_32x32x16_bf16 v[80:95], v[240:243], v[164:167], v[80:95]
    ds_read_b64_tr_b16 v[240:241], v9 offset:51200
    ds_read_b64_tr_b16 v[242:243], v9 offset:52480
    s_nop 0
    v_cvt_pk_bf16_f32 v112, v64, v65
    v_cvt_pk_bf16_f32 v113, v66, v67
    v_cvt_pk_bf16_f32 v114, v68, v69
    s_waitcnt lgkmcnt(8)
    v_mfma_f32_32x32x16_bf16 v[80:95], v[224:227], v[168:171], v[80:95]
    ds_read_b64_tr_b16 v[224:225], v9 offset:56320
    ds_read_b64_tr_b16 v[226:227], v9 offset:57600
    v_cvt_pk_bf16_f32 v115, v70, v71
    buffer_store_dwordx4 v[112:115], v13, s[32:35], s100 offen offset:0 sc1
    v_cvt_pk_bf16_f32 v116, v72, v73
    s_waitcnt lgkmcnt(8)
    v_mfma_f32_32x32x16_bf16 v[80:95], v[228:231], v[172:175], v[80:95]
    v_add_u32 v9, 0xffff1000, v9
    ds_read_b64_tr_b16 v[228:229], v9 offset:0
    ds_read_b64_tr_b16 v[230:231], v9 offset:1280
    v_cvt_pk_bf16_f32 v117, v74, v75
    v_cvt_pk_bf16_f32 v118, v76, v77
    v_cvt_pk_bf16_f32 v119, v78, v79
    s_waitcnt lgkmcnt(8)
    v_mfma_f32_32x32x16_bf16 v[80:95], v[232:235], v[176:179], v[80:95]
    ds_read_b64_tr_b16 v[232:233], v9 offset:25600
    ds_read_b64_tr_b16 v[234:235], v9 offset:26880
    buffer_store_dwordx4 v[116:119], v13, s[32:35], s100 offen offset:1024 sc1
    s_waitcnt lgkmcnt(8)
    v_mfma_f32_32x32x16_bf16 v[80:95], v[236:239], v[180:183], v[80:95]
    ds_read_b64_tr_b16 v[236:237], v9 offset:30720
    ds_read_b64_tr_b16 v[238:239], v9 offset:32000
    s_waitcnt lgkmcnt(8)
    v_mfma_f32_32x32x16_bf16 v[80:95], v[240:243], v[184:187], v[80:95]
    ds_read_b64_tr_b16 v[240:241], v9 offset:35840
    ds_read_b64_tr_b16 v[242:243], v9 offset:37120
    s_waitcnt lgkmcnt(8)
    v_mfma_f32_32x32x16_bf16 v[80:95], v[224:227], v[188:191], v[80:95]
    ds_read_b64_tr_b16 v[224:225], v9 offset:40960
    ds_read_b64_tr_b16 v[226:227], v9 offset:42240
    s_waitcnt lgkmcnt(8)
    v_mfma_f32_32x32x16_bf16 v[80:95], v[228:231], v[192:195], v[80:95]
    ds_read_b64_tr_b16 v[228:229], v9 offset:46080
    ds_read_b64_tr_b16 v[230:231], v9 offset:47360
    s_waitcnt lgkmcnt(8)
    v_mfma_f32_32x32x16_bf16 v[80:95], v[232:235], v[196:199], v[80:95]
    ds_read_b64_tr_b16 v[232:233], v9 offset:51200
    ds_read_b64_tr_b16 v[234:235], v9 offset:52480
    s_waitcnt lgkmcnt(8)
    v_mfma_f32_32x32x16_bf16 v[80:95], v[236:239], v[200:203], v[80:95]
    ds_read_b64_tr_b16 v[236:237], v9 offset:56320
    ds_read_b64_tr_b16 v[238:239], v9 offset:57600
    s_waitcnt lgkmcnt(8)
    v_mfma_f32_32x32x16_bf16 v[80:95], v[240:243], v[204:207], v[80:95]
    ds_read_b64_tr_b16 v[240:241], v5 offset:46080
    ds_read_b64_tr_b16 v[242:243], v5 offset:47360
    s_waitcnt lgkmcnt(8)
    v_mfma_f32_32x32x16_bf16 v[80:95], v[224:227], v[208:211], v[80:95]
    ds_read_b64_tr_b16 v[224:225], v5 offset:51200
    ds_read_b64_tr_b16 v[226:227], v5 offset:52480
    s_waitcnt lgkmcnt(8)
    v_mfma_f32_32x32x16_bf16 v[80:95], v[228:231], v[212:215], v[80:95]
    ds_read_b64_tr_b16 v[228:229], v5 offset:56320
    ds_read_b64_tr_b16 v[230:231], v5 offset:57600
    s_waitcnt lgkmcnt(8)
    v_mfma_f32_32x32x16_bf16 v[80:95], v[232:235], v[216:219], v[80:95]
    v_add_u32 v5, 0xa000, v5
    ds_read_b64_tr_b16 v[232:233], v5 offset:20480
    ds_read_b64_tr_b16 v[234:235], v5 offset:21760
    s_waitcnt lgkmcnt(8)
    v_mfma_f32_32x32x16_bf16 v[80:95], v[236:239], v[220:223], v[80:95]
    v_add_u32 v5, 0xf000, v5
    ds_read_b64_tr_b16 v[236:237], v5 offset:40960
    ds_read_b64_tr_b16 v[238:239], v5 offset:42240
    s_waitcnt lgkmcnt(8)
    v_mfma_f32_32x32x16_bf16 v[16:31], v[240:243], v[160:163], v[16:31]
    ds_read_b64_tr_b16 v[240:241], v5 offset:46080
    ds_read_b64_tr_b16 v[242:243], v5 offset:47360
    s_waitcnt lgkmcnt(8)
    v_mfma_f32_32x32x16_bf16 v[16:31], v[224:227], v[164:167], v[16:31]
    ds_read_b64_tr_b16 v[224:225], v5 offset:51200
    ds_read_b64_tr_b16 v[226:227], v5 offset:52480
    s_nop 0
    v_cvt_pk_bf16_f32 v120, v80, v81
    v_cvt_pk_bf16_f32 v121, v82, v83
    v_cvt_pk_bf16_f32 v122, v84, v85
    s_waitcnt lgkmcnt(8)
    v_mfma_f32_32x32x16_bf16 v[16:31], v[228:231], v[168:171], v[16:31]
    ds_read_b64_tr_b16 v[228:229], v5 offset:56320
    ds_read_b64_tr_b16 v[230:231], v5 offset:57600
    v_cvt_pk_bf16_f32 v123, v86, v87
    buffer_store_dwordx4 v[120:123], v13, s[32:35], s101 offen offset:2048 sc1
    v_cvt_pk_bf16_f32 v124, v88, v89
    s_waitcnt lgkmcnt(8)
    v_mfma_f32_32x32x16_bf16 v[16:31], v[232:235], v[172:175], v[16:31]
    v_add_u32 v5, 0xffff1000, v5
    ds_read_b64_tr_b16 v[232:233], v5 offset:0
    ds_read_b64_tr_b16 v[234:235], v5 offset:1280
    v_cvt_pk_bf16_f32 v125, v90, v91
    v_cvt_pk_bf16_f32 v126, v92, v93
    v_cvt_pk_bf16_f32 v127, v94, v95
    s_waitcnt lgkmcnt(8)
    v_mfma_f32_32x32x16_bf16 v[16:31], v[236:239], v[176:179], v[16:31]
    ds_read_b64_tr_b16 v[236:237], v5 offset:25600
    ds_read_b64_tr_b16 v[238:239], v5 offset:26880
    buffer_store_dwordx4 v[124:127], v13, s[32:35], s101 offen offset:3072 sc1
    s_waitcnt lgkmcnt(8)
    v_mfma_f32_32x32x16_bf16 v[16:31], v[240:243], v[180:183], v[16:31]
    ds_read_b64_tr_b16 v[240:241], v5 offset:30720
    ds_read_b64_tr_b16 v[242:243], v5 offset:32000
    s_waitcnt lgkmcnt(8)
    v_mfma_f32_32x32x16_bf16 v[16:31], v[224:227], v[184:187], v[16:31]
    ds_read_b64_tr_b16 v[224:225], v5 offset:35840
    ds_read_b64_tr_b16 v[226:227], v5 offset:37120
    s_waitcnt vmcnt(0)
    s_lshl2_add_u32 s97, s42, s58
    v_mov_b32 v254, 1
    v_mov_b32 v255, 0
    s_mov_b64 exec, 1
    buffer_store_dword v254, v255, s[32:35], s97 offen offset:0 sc1
    s_mov_b64 exec, -1
    s_waitcnt lgkmcnt(8)
    v_mfma_f32_32x32x16_bf16 v[16:31], v[228:231], v[188:191], v[16:31]
    ds_read_b64_tr_b16 v[228:229], v5 offset:40960
    ds_read_b64_tr_b16 v[230:231], v5 offset:42240
    s_waitcnt lgkmcnt(8)
    v_mfma_f32_32x32x16_bf16 v[16:31], v[232:235], v[192:195], v[16:31]
    ds_read_b64_tr_b16 v[232:233], v5 offset:46080
    ds_read_b64_tr_b16 v[234:235], v5 offset:47360
    s_waitcnt lgkmcnt(8)
    v_mfma_f32_32x32x16_bf16 v[16:31], v[236:239], v[196:199], v[16:31]
    ds_read_b64_tr_b16 v[236:237], v5 offset:51200
    ds_read_b64_tr_b16 v[238:239], v5 offset:52480
    s_waitcnt lgkmcnt(8)
    v_mfma_f32_32x32x16_bf16 v[16:31], v[240:243], v[200:203], v[16:31]
    ds_read_b64_tr_b16 v[240:241], v5 offset:56320
    ds_read_b64_tr_b16 v[242:243], v5 offset:57600
    s_waitcnt lgkmcnt(8)
    v_mfma_f32_32x32x16_bf16 v[16:31], v[224:227], v[204:207], v[16:31]
    s_waitcnt lgkmcnt(6)
    v_mfma_f32_32x32x16_bf16 v[16:31], v[228:231], v[208:211], v[16:31]
    s_waitcnt lgkmcnt(4)
    v_mfma_f32_32x32x16_bf16 v[16:31], v[232:235], v[212:215], v[16:31]
    s_waitcnt lgkmcnt(2)
    v_mfma_f32_32x32x16_bf16 v[16:31], v[236:239], v[216:219], v[16:31]
    s_waitcnt lgkmcnt(0)
    v_mfma_f32_32x32x16_bf16 v[16:31], v[240:243], v[220:223], v[16:31]
    buffer_load_dword v249, v251, s[32:35], s58 offen sc1
    s_lshl_b32 s49, s42, 14
    s_add_u32 s49, s49, s96
    s_add_u32 s98, s42, 1
    s_and_b32 s98, s98, 3
    s_lshl_b32 s98, s98, 12
    s_add_u32 s98, s98, s49
    s_add_u32 s99, s42, 2
    s_and_b32 s99, s99, 3
    s_lshl_b32 s99, s99, 12
    s_add_u32 s99, s99, s49
    s_add_u32 s100, s42, 3
    s_and_b32 s100, s100, 3
    s_lshl_b32 s100, s100, 12
    s_add_u32 s100, s100, s49
    s_waitcnt vmcnt(0)
    v_cmp_ne_u32 vcc, 1, v249
    s_cbranch_vccnz SPINF3
SPINF3_OUT:
    buffer_load_dwordx4 v[136:139], v13, s[32:35], s98 offen offset:0 sc1
    buffer_load_dwordx4 v[140:143], v13, s[32:35], s98 offen offset:1024 sc1
    buffer_load_dwordx4 v[144:147], v13, s[32:35], s99 offen offset:0 sc1
    buffer_load_dwordx4 v[148:151], v13, s[32:35], s99 offen offset:1024 sc1
    buffer_load_dwordx4 v[152:155], v13, s[32:35], s100 offen offset:0 sc1
    buffer_load_dwordx4 v[156:159], v13, s[32:35], s100 offen offset:1024 sc1
    s_cmp_lg_u32 s42, s4
    s_cbranch_scc1 H2_NOX
    buffer_load_dwordx4 v[160:163], v13, s[32:35], s98 offen offset:2048 sc1
    buffer_load_dwordx4 v[164:167], v13, s[32:35], s98 offen offset:3072 sc1
    buffer_load_dwordx4 v[168:171], v13, s[32:35], s99 offen offset:2048 sc1
    buffer_load_dwordx4 v[172:175], v13, s[32:35], s99 offen offset:3072 sc1
    buffer_load_dwordx4 v[176:179], v13, s[32:35], s100 offen offset:2048 sc1
    buffer_load_dwordx4 v[180:183], v13, s[32:35], s100 offen offset:3072 sc1
H2_NOX:
    s_waitcnt vmcnt(0)
    v_lshlrev_b32 v96, 16, v136
    v_and_b32 v97, 0xffff0000, v136
    v_lshlrev_b32 v98, 16, v137
    v_and_b32 v99, 0xffff0000, v137
    v_lshlrev_b32 v100, 16, v138
    v_and_b32 v101, 0xffff0000, v138
    v_lshlrev_b32 v102, 16, v139
    v_and_b32 v103, 0xffff0000, v139
    v_add_f32 v16, v96, v16
    v_add_f32 v17, v97, v17
    v_add_f32 v18, v98, v18
    v_add_f32 v19, v99, v19
    v_add_f32 v20, v100, v20
    v_add_f32 v21, v101, v21
    v_add_f32 v22, v102, v22
    v_add_f32 v23, v103, v23
    v_lshlrev_b32 v96, 16, v144
    v_and_b32 v97, 0xffff0000, v144
    v_lshlrev_b32 v98, 16, v145
    v_and_b32 v99, 0xffff0000, v145
    v_lshlrev_b32 v100, 16, v146
    v_and_b32 v101, 0xffff0000, v146
    v_lshlrev_b32 v102, 16, v147
    v_and_b32 v103, 0xffff0000, v147
    v_add_f32 v16, v96, v16
    v_add_f32 v17, v97, v17
    v_add_f32 v18, v98, v18
    v_add_f32 v19, v99, v19
    v_add_f32 v20, v100, v20
    v_add_f32 v21, v101, v21
    v_add_f32 v22, v102, v22
    v_add_f32 v23, v103, v23
    v_lshlrev_b32 v96, 16, v152
    v_and_b32 v97, 0xffff0000, v152
    v_lshlrev_b32 v98, 16, v153
    v_and_b32 v99, 0xffff0000, v153
    v_lshlrev_b32 v100, 16, v154
    v_and_b32 v101, 0xffff0000, v154
    v_lshlrev_b32 v102, 16, v155
    v_and_b32 v103, 0xffff0000, v155
    v_add_f32 v16, v96, v16
    v_add_f32 v17, v97, v17
    v_add_f32 v18, v98, v18
    v_add_f32 v19, v99, v19
    v_add_f32 v20, v100, v20
    v_add_f32 v21, v101, v21
    v_add_f32 v22, v102, v22
    v_add_f32 v23, v103, v23
    v_cvt_pk_bf16_f32 v104, v16, v17
    v_cvt_pk_bf16_f32 v105, v18, v19
    v_cvt_pk_bf16_f32 v106, v20, v21
    v_cvt_pk_bf16_f32 v107, v22, v23
    buffer_store_dwordx4 v[104:107], v250, s[28:31], s51 offen offset:0
    v_lshlrev_b32 v96, 16, v140
    v_and_b32 v97, 0xffff0000, v140
    v_lshlrev_b32 v98, 16, v141
    v_and_b32 v99, 0xffff0000, v141
    v_lshlrev_b32 v100, 16, v142
    v_and_b32 v101, 0xffff0000, v142
    v_lshlrev_b32 v102, 16, v143
    v_and_b32 v103, 0xffff0000, v143
    v_add_f32 v24, v96, v24
    v_add_f32 v25, v97, v25
    v_add_f32 v26, v98, v26
    v_add_f32 v27, v99, v27
    v_add_f32 v28, v100, v28
    v_add_f32 v29, v101, v29
    v_add_f32 v30, v102, v30
    v_add_f32 v31, v103, v31
    v_lshlrev_b32 v96, 16, v148
    v_and_b32 v97, 0xffff0000, v148
    v_lshlrev_b32 v98, 16, v149
    v_and_b32 v99, 0xffff0000, v149
    v_lshlrev_b32 v100, 16, v150
    v_and_b32 v101, 0xffff0000, v150
    v_lshlrev_b32 v102, 16, v151
    v_and_b32 v103, 0xffff0000, v151
    v_add_f32 v24, v96, v24
    v_add_f32 v25, v97, v25
    v_add_f32 v26, v98, v26
    v_add_f32 v27, v99, v27
    v_add_f32 v28, v100, v28
    v_add_f32 v29, v101, v29
    v_add_f32 v30, v102, v30
    v_add_f32 v31, v103, v31
    v_lshlrev_b32 v96, 16, v156
    v_and_b32 v97, 0xffff0000, v156
    v_lshlrev_b32 v98, 16, v157
    v_and_b32 v99, 0xffff0000, v157
    v_lshlrev_b32 v100, 16, v158
    v_and_b32 v101, 0xffff0000, v158
    v_lshlrev_b32 v102, 16, v159
    v_and_b32 v103, 0xffff0000, v159
    v_add_f32 v24, v96, v24
    v_add_f32 v25, v97, v25
    v_add_f32 v26, v98, v26
    v_add_f32 v27, v99, v27
    v_add_f32 v28, v100, v28
    v_add_f32 v29, v101, v29
    v_add_f32 v30, v102, v30
    v_add_f32 v31, v103, v31
    v_cvt_pk_bf16_f32 v108, v24, v25
    v_cvt_pk_bf16_f32 v109, v26, v27
    v_cvt_pk_bf16_f32 v110, v28, v29
    v_cvt_pk_bf16_f32 v111, v30, v31
    buffer_store_dwordx4 v[108:111], v250, s[28:31], s51 offen offset:32
    s_cmp_lg_u32 s42, s4
    s_cbranch_scc1 H2_END
    v_lshlrev_b32 v96, 16, v160
    v_and_b32 v97, 0xffff0000, v160
    v_lshlrev_b32 v98, 16, v161
    v_and_b32 v99, 0xffff0000, v161
    v_lshlrev_b32 v100, 16, v162
    v_and_b32 v101, 0xffff0000, v162
    v_lshlrev_b32 v102, 16, v163
    v_and_b32 v103, 0xffff0000, v163
    v_add_f32 v80, v96, v80
    v_add_f32 v81, v97, v81
    v_add_f32 v82, v98, v82
    v_add_f32 v83, v99, v83
    v_add_f32 v84, v100, v84
    v_add_f32 v85, v101, v85
    v_add_f32 v86, v102, v86
    v_add_f32 v87, v103, v87
    v_lshlrev_b32 v96, 16, v168
    v_and_b32 v97, 0xffff0000, v168
    v_lshlrev_b32 v98, 16, v169
    v_and_b32 v99, 0xffff0000, v169
    v_lshlrev_b32 v100, 16, v170
    v_and_b32 v101, 0xffff0000, v170
    v_lshlrev_b32 v102, 16, v171
    v_and_b32 v103, 0xffff0000, v171
    v_add_f32 v80, v96, v80
    v_add_f32 v81, v97, v81
    v_add_f32 v82, v98, v82
    v_add_f32 v83, v99, v83
    v_add_f32 v84, v100, v84
    v_add_f32 v85, v101, v85
    v_add_f32 v86, v102, v86
    v_add_f32 v87, v103, v87
    v_lshlrev_b32 v96, 16, v176
    v_and_b32 v97, 0xffff0000, v176
    v_lshlrev_b32 v98, 16, v177
    v_and_b32 v99, 0xffff0000, v177
    v_lshlrev_b32 v100, 16, v178
    v_and_b32 v101, 0xffff0000, v178
    v_lshlrev_b32 v102, 16, v179
    v_and_b32 v103, 0xffff0000, v179
    v_add_f32 v80, v96, v80
    v_add_f32 v81, v97, v81
    v_add_f32 v82, v98, v82
    v_add_f32 v83, v99, v83
    v_add_f32 v84, v100, v84
    v_add_f32 v85, v101, v85
    v_add_f32 v86, v102, v86
    v_add_f32 v87, v103, v87
    v_cvt_pk_bf16_f32 v112, v80, v81
    v_cvt_pk_bf16_f32 v113, v82, v83
    v_cvt_pk_bf16_f32 v114, v84, v85
    v_cvt_pk_bf16_f32 v115, v86, v87
    buffer_store_dwordx4 v[112:115], v250, s[28:31], s52 offen offset:256
    v_lshlrev_b32 v96, 16, v164
    v_and_b32 v97, 0xffff0000, v164
    v_lshlrev_b32 v98, 16, v165
    v_and_b32 v99, 0xffff0000, v165
    v_lshlrev_b32 v100, 16, v166
    v_and_b32 v101, 0xffff0000, v166
    v_lshlrev_b32 v102, 16, v167
    v_and_b32 v103, 0xffff0000, v167
    v_add_f32 v88, v96, v88
    v_add_f32 v89, v97, v89
    v_add_f32 v90, v98, v90
    v_add_f32 v91, v99, v91
    v_add_f32 v92, v100, v92
    v_add_f32 v93, v101, v93
    v_add_f32 v94, v102, v94
    v_add_f32 v95, v103, v95
    v_lshlrev_b32 v96, 16, v172
    v_and_b32 v97, 0xffff0000, v172
    v_lshlrev_b32 v98, 16, v173
    v_and_b32 v99, 0xffff0000, v173
    v_lshlrev_b32 v100, 16, v174
    v_and_b32 v101, 0xffff0000, v174
    v_lshlrev_b32 v102, 16, v175
    v_and_b32 v103, 0xffff0000, v175
    v_add_f32 v88, v96, v88
    v_add_f32 v89, v97, v89
    v_add_f32 v90, v98, v90
    v_add_f32 v91, v99, v91
    v_add_f32 v92, v100, v92
    v_add_f32 v93, v101, v93
    v_add_f32 v94, v102, v94
    v_add_f32 v95, v103, v95
    v_lshlrev_b32 v96, 16, v180
    v_and_b32 v97, 0xffff0000, v180
    v_lshlrev_b32 v98, 16, v181
    v_and_b32 v99, 0xffff0000, v181
    v_lshlrev_b32 v100, 16, v182
    v_and_b32 v101, 0xffff0000, v182
    v_lshlrev_b32 v102, 16, v183
    v_and_b32 v103, 0xffff0000, v183
    v_add_f32 v88, v96, v88
    v_add_f32 v89, v97, v89
    v_add_f32 v90, v98, v90
    v_add_f32 v91, v99, v91
    v_add_f32 v92, v100, v92
    v_add_f32 v93, v101, v93
    v_add_f32 v94, v102, v94
    v_add_f32 v95, v103, v95
    v_cvt_pk_bf16_f32 v116, v88, v89
    v_cvt_pk_bf16_f32 v117, v90, v91
    v_cvt_pk_bf16_f32 v118, v92, v93
    v_cvt_pk_bf16_f32 v119, v94, v95
    buffer_store_dwordx4 v[116:119], v250, s[28:31], s52 offen offset:288
H2_END:
    s_endpgm
G1_FIN:
    v_mfma_f32_32x32x16_bf16 v[32:47], v[184:187], v[160:163], v[32:47]
    s_add_u32 s46, s63, 0xb400
    v_add_u32 v224, s46, v13
    v_add_u32 v225, 0x17c00, v224
    v_mfma_f32_32x32x16_bf16 v[32:47], v[188:191], v[164:167], v[32:47]
    v_mfma_f32_32x32x16_bf16 v[48:63], v[192:195], v[160:163], v[48:63]
    v_mul_f32 v16, v238, v16
    v_mul_f32 v17, v238, v17
    v_mul_f32 v18, v238, v18
    v_mul_f32 v19, v238, v19
    v_mul_f32 v20, v238, v20
    v_mul_f32 v21, v238, v21
    v_mul_f32 v22, v238, v22
    v_mul_f32 v23, v238, v23
    v_cvt_pk_bf16_f32 v96, v16, v17
    v_cvt_pk_bf16_f32 v97, v18, v19
    v_cvt_pk_bf16_f32 v98, v20, v21
    v_cvt_pk_bf16_f32 v99, v22, v23
    buffer_store_dwordx4 v[96:99], v13, s[32:35], s98 offen offset:0 sc1
    v_mfma_f32_32x32x16_bf16 v[48:63], v[196:199], v[164:167], v[48:63]
    v_mul_f32 v24, v238, v24
    v_mul_f32 v25, v238, v25
    v_mul_f32 v26, v238, v26
    v_mul_f32 v27, v238, v27
    v_mul_f32 v28, v238, v28
    v_mul_f32 v29, v238, v29
    v_mul_f32 v30, v238, v30
    v_mul_f32 v31, v238, v31
    v_cvt_pk_bf16_f32 v100, v24, v25
    v_cvt_pk_bf16_f32 v101, v26, v27
    v_cvt_pk_bf16_f32 v102, v28, v29
    v_cvt_pk_bf16_f32 v103, v30, v31
    buffer_store_dwordx4 v[100:103], v13, s[32:35], s98 offen offset:1024 sc1
    v_mfma_f32_32x32x16_bf16 v[64:79], v[200:203], v[160:163], v[64:79]
    v_mul_f32 v32, v238, v32
    v_mul_f32 v33, v238, v33
    v_mul_f32 v34, v238, v34
    v_mul_f32 v35, v238, v35
    v_mul_f32 v36, v238, v36
    v_mul_f32 v37, v238, v37
    v_mul_f32 v38, v238, v38
    v_mul_f32 v39, v238, v39
    v_cvt_pk_bf16_f32 v104, v32, v33
    v_cvt_pk_bf16_f32 v105, v34, v35
    v_cvt_pk_bf16_f32 v106, v36, v37
    v_cvt_pk_bf16_f32 v107, v38, v39
    buffer_store_dwordx4 v[104:107], v13, s[32:35], s98 offen offset:2048 sc1
    v_mfma_f32_32x32x16_bf16 v[64:79], v[204:207], v[164:167], v[64:79]
    v_mul_f32 v40, v238, v40
    v_mul_f32 v41, v238, v41
    v_mul_f32 v42, v238, v42
    v_mul_f32 v43, v238, v43
    v_mul_f32 v44, v238, v44
    v_mul_f32 v45, v238, v45
    v_mul_f32 v46, v238, v46
    v_mul_f32 v47, v238, v47
    v_cvt_pk_bf16_f32 v108, v40, v41
    v_cvt_pk_bf16_f32 v109, v42, v43
    v_cvt_pk_bf16_f32 v110, v44, v45
    v_cvt_pk_bf16_f32 v111, v46, v47
    buffer_store_dwordx4 v[108:111], v13, s[32:35], s98 offen offset:3072 sc1
    v_mul_f32 v48, v238, v48
    v_mul_f32 v49, v238, v49
    v_mul_f32 v50, v238, v50
    v_mul_f32 v51, v238, v51
    v_mul_f32 v52, v238, v52
    v_mul_f32 v53, v238, v53
    v_mul_f32 v54, v238, v54
    v_mul_f32 v55, v238, v55
    v_cvt_pk_bf16_f32 v112, v48, v49
    v_cvt_pk_bf16_f32 v113, v50, v51
    v_cvt_pk_bf16_f32 v114, v52, v53
    v_cvt_pk_bf16_f32 v115, v54, v55
    buffer_store_dwordx4 v[112:115], v13, s[32:35], s99 offen offset:0 sc1
    v_mul_f32 v56, v238, v56
    v_mul_f32 v57, v238, v57
    v_mul_f32 v58, v238, v58
    v_mul_f32 v59, v238, v59
    v_mul_f32 v60, v238, v60
    v_mul_f32 v61, v238, v61
    v_mul_f32 v62, v238, v62
    v_mul_f32 v63, v238, v63
    v_cvt_pk_bf16_f32 v116, v56, v57
    v_cvt_pk_bf16_f32 v117, v58, v59
    v_cvt_pk_bf16_f32 v118, v60, v61
    v_cvt_pk_bf16_f32 v119, v62, v63
    buffer_store_dwordx4 v[116:119], v13, s[32:35], s99 offen offset:1024 sc1
    v_mul_f32 v64, v238, v64
    v_mul_f32 v65, v238, v65
    v_mul_f32 v66, v238, v66
    v_mul_f32 v67, v238, v67
    v_mul_f32 v68, v238, v68
    v_mul_f32 v69, v238, v69
    v_mul_f32 v70, v238, v70
    v_mul_f32 v71, v238, v71
    v_cvt_pk_bf16_f32 v120, v64, v65
    v_cvt_pk_bf16_f32 v121, v66, v67
    v_cvt_pk_bf16_f32 v122, v68, v69
    v_cvt_pk_bf16_f32 v123, v70, v71
    buffer_store_dwordx4 v[120:123], v13, s[32:35], s99 offen offset:2048 sc1
    v_mul_f32 v72, v238, v72
    v_mul_f32 v73, v238, v73
    v_mul_f32 v74, v238, v74
    v_mul_f32 v75, v238, v75
    v_mul_f32 v76, v238, v76
    v_mul_f32 v77, v238, v77
    v_mul_f32 v78, v238, v78
    v_mul_f32 v79, v238, v79
    v_cvt_pk_bf16_f32 v124, v72, v73
    v_cvt_pk_bf16_f32 v125, v74, v75
    v_cvt_pk_bf16_f32 v126, v76, v77
    v_cvt_pk_bf16_f32 v127, v78, v79
    buffer_store_dwordx4 v[124:127], v13, s[32:35], s99 offen offset:3072 sc1
    s_barrier
    ds_write_b128 v224, v[96:99] offset:0
    ds_write_b128 v224, v[100:103] offset:1024
    ds_write_b128 v224, v[104:107] offset:2048
    ds_write_b128 v224, v[108:111] offset:3072
    ds_write_b128 v224, v[112:115] offset:4096
    ds_write_b128 v225, v[116:119] offset:0
    ds_write_b128 v225, v[120:123] offset:1024
    ds_write_b128 v225, v[124:127] offset:2048
    s_waitcnt vmcnt(0)
    s_lshl2_add_u32 s97, s41, s57
    v_mov_b32 v254, 1
    v_mov_b32 v255, 0
    s_mov_b64 exec, 1
    buffer_store_dword v254, v255, s[32:35], s97 offen offset:128 sc1
    s_mov_b64 exec, -1
    s_waitcnt lgkmcnt(0)
    s_barrier
    s_barrier
    s_lshl1_add_u32 s47, s41, 4
    s_and_b32 s47, s47, 7
    s_mul_i32 s47, s47, 81920
    s_add_u32 s47, s47, s59
    s_add_u32 s47, s47, 0x280000
    s_add_u32 s49, s63, 0xb400
    s_add_u32 m0, s49, 0
    s_nop 0
    buffer_load_dwordx4 v244, s[24:27], s47 offen lds
    s_add_u32 m0, s49, 1024
    s_nop 0
    buffer_load_dwordx4 v245, s[24:27], s47 offen lds
    s_add_u32 m0, s49, 2048
    s_nop 0
    buffer_load_dwordx4 v246, s[24:27], s47 offen lds
    s_add_u32 m0, s49, 3072
    s_nop 0
    buffer_load_dwordx4 v247, s[24:27], s47 offen lds
    s_add_u32 m0, s49, 4096
    s_nop 0
    buffer_load_dwordx4 v248, s[24:27], s47 offen lds
    s_lshl1_add_u32 s47, s41, 5
    s_and_b32 s47, s47, 7
    s_mul_i32 s47, s47, 81920
    s_add_u32 s47, s47, s59
    s_add_u32 s47, s47, 0x280000
    s_add_u32 s49, s63, 0x23000
    s_add_u32 m0, s49, 0
    s_nop 0
    buffer_load_dwordx4 v244, s[24:27], s47 offen lds
    s_add_u32 m0, s49, 1024
    s_nop 0
    buffer_load_dwordx4 v245, s[24:27], s47 offen lds
    s_add_u32 m0, s49, 2048
    s_nop 0
    buffer_load_dwordx4 v246, s[24:27], s47 offen lds
    s_add_u32 m0, s49, 3072
    s_nop 0
    buffer_load_dwordx4 v247, s[24:27], s47 offen lds
    s_add_u32 m0, s49, 4096
    s_nop 0
    buffer_load_dwordx4 v248, s[24:27], s47 offen lds
    s_barrier
    s_lshl1_add_u32 s47, s41, 6
    s_and_b32 s47, s47, 7
    s_mul_i32 s47, s47, 81920
    s_add_u32 s47, s47, s59
    s_add_u32 s47, s47, 0x280000
    s_add_u32 s49, s63, 0xf000
    s_cmp_eq_u32 s4, 0
    s_cselect_b32 s49, 0xa000, s49
    s_add_u32 m0, s49, 0
    s_nop 0
    buffer_load_dwordx4 v244, s[24:27], s47 offen lds
    s_add_u32 m0, s49, 1024
    s_nop 0
    buffer_load_dwordx4 v245, s[24:27], s47 offen lds
    s_add_u32 m0, s49, 2048
    s_nop 0
    buffer_load_dwordx4 v246, s[24:27], s47 offen lds
    s_add_u32 m0, s49, 3072
    s_nop 0
    buffer_load_dwordx4 v247, s[24:27], s47 offen lds
    s_add_u32 m0, s49, 4096
    s_nop 0
    buffer_load_dwordx4 v248, s[24:27], s47 offen lds
    s_lshl1_add_u32 s47, s41, 7
    s_and_b32 s47, s47, 7
    s_mul_i32 s47, s47, 81920
    s_add_u32 s47, s47, s59
    s_add_u32 s47, s47, 0x280000
    s_add_u32 s49, s63, 0x14000
    s_add_u32 m0, s49, 0
    s_nop 0
    buffer_load_dwordx4 v244, s[24:27], s47 offen lds
    s_add_u32 m0, s49, 1024
    s_nop 0
    buffer_load_dwordx4 v245, s[24:27], s47 offen lds
    s_add_u32 m0, s49, 2048
    s_nop 0
    buffer_load_dwordx4 v246, s[24:27], s47 offen lds
    s_add_u32 m0, s49, 3072
    s_nop 0
    buffer_load_dwordx4 v247, s[24:27], s47 offen lds
    s_add_u32 m0, s49, 4096
    s_nop 0
    buffer_load_dwordx4 v248, s[24:27], s47 offen lds
    s_waitcnt vmcnt(0)
    s_endpgm
SPINC:
    s_mov_b32 s43, 0x40000
SPINC_L:
    s_sub_u32 s43, s43, 1
    s_cbranch_scc1 SPINC_OUT
    s_sleep 2
    buffer_load_dword v250, v252, s[36:39], 0 offen sc1
    s_waitcnt vmcnt(0)
    v_cmp_gt_u32 vcc, 16, v250
    s_cbranch_vccnz SPINC_L
    s_branch SPINC_OUT
SPINF1:
    s_mov_b32 s43, 0x40000
SPINF1_L:
    s_sub_u32 s43, s43, 1
    s_cbranch_scc1 SPINF1_OUT
    s_sleep 2
    buffer_load_dword v249, v251, s[32:35], s57 offen sc1
    s_waitcnt vmcnt(0)
    v_cmp_ne_u32 vcc, 1, v249
    s_cbranch_vccnz SPINF1_L
    s_branch SPINF1_OUT
SPINF2:
    s_mov_b32 s43, 0x40000
SPINF2_L:
    s_sub_u32 s43, s43, 1
    s_cbranch_scc1 SPINF2_OUT
    s_sleep 2
    buffer_load_dword v249, v251, s[32:35], s57 offen offset:128 sc1
    s_waitcnt vmcnt(0)
    v_cmp_ne_u32 vcc, 1, v249
    s_cbranch_vccnz SPINF2_L
    s_branch SPINF2_OUT
SPINF3:
    s_mov_b32 s43, 0x40000
SPINF3_L:
    s_sub_u32 s43, s43, 1
    s_cbranch_scc1 SPINF3_OUT
    s_sleep 2
    buffer_load_dword v249, v251, s[32:35], s58 offen sc1
    s_waitcnt vmcnt(0)
    v_cmp_ne_u32 vcc, 1, v249
    s_cbranch_vccnz SPINF3_L
    s_branch SPINF3_OUT
SLOW_A:
    s_nop 7
    s_nop 7
    v_mov_b32 v237, v236
    s_nop 1
    v_permlane32_swap_b32 v236, v237
    v_max3_f32 v236, v236, v237, 0
    v_exp_f32 v240, -v236
    v_sub_f32 v144, v144, v236
    v_sub_f32 v145, v145, v236
    v_sub_f32 v146, v146, v236
    v_sub_f32 v147, v147, v236
    v_sub_f32 v148, v148, v236
    v_sub_f32 v149, v149, v236
    v_sub_f32 v150, v150, v236
    v_sub_f32 v151, v151, v236
    v_sub_f32 v152, v152, v236
    v_sub_f32 v153, v153, v236
    v_sub_f32 v154, v154, v236
    v_sub_f32 v155, v155, v236
    v_sub_f32 v156, v156, v236
    v_sub_f32 v157, v157, v236
    v_sub_f32 v158, v158, v236
    v_sub_f32 v159, v159, v236
    v_sub_f32 v160, v160, v236
    v_sub_f32 v161, v161, v236
    v_sub_f32 v162, v162, v236
    v_sub_f32 v163, v163, v236
    v_sub_f32 v164, v164, v236
    v_sub_f32 v165, v165, v236
    v_sub_f32 v166, v166, v236
    v_sub_f32 v167, v167, v236
    v_sub_f32 v168, v168, v236
    v_sub_f32 v169, v169, v236
    v_sub_f32 v170, v170, v236
    v_sub_f32 v171, v171, v236
    v_sub_f32 v172, v172, v236
    v_sub_f32 v173, v173, v236
    v_sub_f32 v174, v174, v236
    v_sub_f32 v175, v175, v236
    v_sub_f32 v208, v208, v236
    v_sub_f32 v209, v209, v236
    v_sub_f32 v210, v210, v236
    v_sub_f32 v211, v211, v236
    v_sub_f32 v212, v212, v236
    v_sub_f32 v213, v213, v236
    v_sub_f32 v214, v214, v236
    v_sub_f32 v215, v215, v236
    v_sub_f32 v216, v216, v236
    v_sub_f32 v217, v217, v236
    v_sub_f32 v218, v218, v236
    v_sub_f32 v219, v219, v236
    v_sub_f32 v220, v220, v236
    v_sub_f32 v221, v221, v236
    v_sub_f32 v222, v222, v236
    v_sub_f32 v223, v223, v236
    v_mul_f32 v238, v240, v238
    v_mul_f32 v239, v240, v239
    v_mul_f32 v16, v240, v16
    v_mul_f32 v17, v240, v17
    v_mul_f32 v18, v240, v18
    v_mul_f32 v19, v240, v19
    v_mul_f32 v20, v240, v20
    v_mul_f32 v21, v240, v21
    v_mul_f32 v22, v240, v22
    v_mul_f32 v23, v240, v23
    v_mul_f32 v24, v240, v24
    v_mul_f32 v25, v240, v25
    v_mul_f32 v26, v240, v26
    v_mul_f32 v27, v240, v27
    v_mul_f32 v28, v240, v28
    v_mul_f32 v29, v240, v29
    v_mul_f32 v30, v240, v30
    v_mul_f32 v31, v240, v31
    v_mul_f32 v32, v240, v32
    v_mul_f32 v33, v240, v33
    v_mul_f32 v34, v240, v34
    v_mul_f32 v35, v240, v35
    v_mul_f32 v36, v240, v36
    v_mul_f32 v37, v240, v37
    v_mul_f32 v38, v240, v38
    v_mul_f32 v39, v240, v39
    v_mul_f32 v40, v240, v40
    v_mul_f32 v41, v240, v41
    v_mul_f32 v42, v240, v42
    v_mul_f32 v43, v240, v43
    v_mul_f32 v44, v240, v44
    v_mul_f32 v45, v240, v45
    v_mul_f32 v46, v240, v46
    v_mul_f32 v47, v240, v47
    v_mul_f32 v48, v240, v48
    v_mul_f32 v49, v240, v49
    v_mul_f32 v50, v240, v50
    v_mul_f32 v51, v240, v51
    v_mul_f32 v52, v240, v52
    v_mul_f32 v53, v240, v53
    v_mul_f32 v54, v240, v54
    v_mul_f32 v55, v240, v55
    v_mul_f32 v56, v240, v56
    v_mul_f32 v57, v240, v57
    v_mul_f32 v58, v240, v58
    v_mul_f32 v59, v240, v59
    v_mul_f32 v60, v240, v60
    v_mul_f32 v61, v240, v61
    v_mul_f32 v62, v240, v62
    v_mul_f32 v63, v240, v63
    v_mul_f32 v64, v240, v64
    v_mul_f32 v65, v240, v65
    v_mul_f32 v66, v240, v66
    v_mul_f32 v67, v240, v67
    v_mul_f32 v68, v240, v68
    v_mul_f32 v69, v240, v69
    v_mul_f32 v70, v240, v70
    v_mul_f32 v71, v240, v71
    v_mul_f32 v72, v240, v72
    v_mul_f32 v73, v240, v73
    v_mul_f32 v74, v240, v74
    v_mul_f32 v75, v240, v75
    v_mul_f32 v76, v240, v76
    v_mul_f32 v77, v240, v77
    v_mul_f32 v78, v240, v78
    v_mul_f32 v79, v240, v79
    s_branch BACK_A
SLOW_B:
    s_nop 7
    s_nop 7
    v_mov_b32 v237, v236
    s_nop 1
    v_permlane32_swap_b32 v236, v237
    v_max3_f32 v236, v236, v237, 0
    v_exp_f32 v240, -v236
    v_sub_f32 v112, v112, v236
    v_sub_f32 v113, v113, v236
    v_sub_f32 v114, v114, v236
    v_sub_f32 v115, v115, v236
    v_sub_f32 v116, v116, v236
    v_sub_f32 v117, v117, v236
    v_sub_f32 v118, v118, v236
    v_sub_f32 v119, v119, v236
    v_sub_f32 v120, v120, v236
    v_sub_f32 v121, v121, v236
    v_sub_f32 v122, v122, v236
    v_sub_f32 v123, v123, v236
    v_sub_f32 v124, v124, v236
    v_sub_f32 v125, v125, v236
    v_sub_f32 v126, v126, v236
    v_sub_f32 v127, v127, v236
    v_sub_f32 v128, v128, v236
    v_sub_f32 v129, v129, v236
    v_sub_f32 v130, v130, v236
    v_sub_f32 v131, v131, v236
    v_sub_f32 v132, v132, v236
    v_sub_f32 v133, v133, v236
    v_sub_f32 v134, v134, v236
    v_sub_f32 v135, v135, v236
    v_sub_f32 v136, v136, v236
    v_sub_f32 v137, v137, v236
    v_sub_f32 v138, v138, v236
    v_sub_f32 v139, v139, v236
    v_sub_f32 v140, v140, v236
    v_sub_f32 v141, v141, v236
    v_sub_f32 v142, v142, v236
    v_sub_f32 v143, v143, v236
    v_sub_f32 v208, v208, v236
    v_sub_f32 v209, v209, v236
    v_sub_f32 v210, v210, v236
    v_sub_f32 v211, v211, v236
    v_sub_f32 v212, v212, v236
    v_sub_f32 v213, v213, v236
    v_sub_f32 v214, v214, v236
    v_sub_f32 v215, v215, v236
    v_sub_f32 v216, v216, v236
    v_sub_f32 v217, v217, v236
    v_sub_f32 v218, v218, v236
    v_sub_f32 v219, v219, v236
    v_sub_f32 v220, v220, v236
    v_sub_f32 v221, v221, v236
    v_sub_f32 v222, v222, v236
    v_sub_f32 v223, v223, v236
    v_mul_f32 v238, v240, v238
    v_mul_f32 v239, v240, v239
    v_mul_f32 v16, v240, v16
    v_mul_f32 v17, v240, v17
    v_mul_f32 v18, v240, v18
    v_mul_f32 v19, v240, v19
    v_mul_f32 v20, v240, v20
    v_mul_f32 v21, v240, v21
    v_mul_f32 v22, v240, v22
    v_mul_f32 v23, v240, v23
    v_mul_f32 v24, v240, v24
    v_mul_f32 v25, v240, v25
    v_mul_f32 v26, v240, v26
    v_mul_f32 v27, v240, v27
    v_mul_f32 v28, v240, v28
    v_mul_f32 v29, v240, v29
    v_mul_f32 v30, v240, v30
    v_mul_f32 v31, v240, v31
    v_mul_f32 v32, v240, v32
    v_mul_f32 v33, v240, v33
    v_mul_f32 v34, v240, v34
    v_mul_f32 v35, v240, v35
    v_mul_f32 v36, v240, v36
    v_mul_f32 v37, v240, v37
    v_mul_f32 v38, v240, v38
    v_mul_f32 v39, v240, v39
    v_mul_f32 v40, v240, v40
    v_mul_f32 v41, v240, v41
    v_mul_f32 v42, v240, v42
    v_mul_f32 v43, v240, v43
    v_mul_f32 v44, v240, v44
    v_mul_f32 v45, v240, v45
    v_mul_f32 v46, v240, v46
    v_mul_f32 v47, v240, v47
    v_mul_f32 v48, v240, v48
    v_mul_f32 v49, v240, v49
    v_mul_f32 v50, v240, v50
    v_mul_f32 v51, v240, v51
    v_mul_f32 v52, v240, v52
    v_mul_f32 v53, v240, v53
    v_mul_f32 v54, v240, v54
    v_mul_f32 v55, v240, v55
    v_mul_f32 v56, v240, v56
    v_mul_f32 v57, v240, v57
    v_mul_f32 v58, v240, v58
    v_mul_f32 v59, v240, v59
    v_mul_f32 v60, v240, v60
    v_mul_f32 v61, v240, v61
    v_mul_f32 v62, v240, v62
    v_mul_f32 v63, v240, v63
    v_mul_f32 v64, v240, v64
    v_mul_f32 v65, v240, v65
    v_mul_f32 v66, v240, v66
    v_mul_f32 v67, v240, v67
    v_mul_f32 v68, v240, v68
    v_mul_f32 v69, v240, v69
    v_mul_f32 v70, v240, v70
    v_mul_f32 v71, v240, v71
    v_mul_f32 v72, v240, v72
    v_mul_f32 v73, v240, v73
    v_mul_f32 v74, v240, v74
    v_mul_f32 v75, v240, v75
    v_mul_f32 v76, v240, v76
    v_mul_f32 v77, v240, v77
    v_mul_f32 v78, v240, v78
    v_mul_f32 v79, v240, v79
    s_branch BACK_B
G0_START:
    s_getpc_b64 s[98:99]
CPF_PC:
    s_sub_u32 s98, s98, CPF_PC-standalone__gqa_block_cached__near_ridge_kernel
    s_subb_u32 s99, s99, 0
    s_lshr_b32 s100, s2, 3
    s_and_b32 s100, s100, 15
    s_lshl2_add_u32 s100, s100, s4
    s_mul_i32 s100, s100, 1024
    v_lshlrev_b32 v102, 6, v0
    v_add_u32 v102, s100, v102
    v_min_u32 v102, K_END-standalone__gqa_block_cached__near_ridge_kernel, v102
    v_mov_b32 v103, s99
    v_add_co_u32 v102, vcc, s98, v102
    s_nop 1
    v_addc_co_u32 v103, vcc, 0, v103, vcc
    s_mov_b64 exec, 0xffff
    global_load_dword v104, v[102:103], off
    s_mov_b64 exec, -1
    s_waitcnt lgkmcnt(0)
    s_mov_b32 s12, s66
    s_mov_b32 s13, s67
    s_mov_b32 s14, 0x4000000
    s_mov_b32 s15, 0x20000
    s_mov_b32 s16, s68
    s_mov_b32 s17, s69
    s_mov_b32 s18, 0x4000000
    s_mov_b32 s19, 0x20000
    s_mov_b32 s32, s78
    s_mov_b32 s33, s79
    s_mov_b32 s34, 0x2800000
    s_mov_b32 s35, 0x20000
    s_mov_b32 s24, s72
    s_mov_b32 s25, s73
    s_mov_b32 s26, 0x500000
    s_mov_b32 s27, 0x20000
    s_mov_b32 s28, s74
    s_mov_b32 s29, s75
    s_mov_b32 s30, 0x280000
    s_mov_b32 s31, 0x20000
    s_mov_b32 s36, s76
    s_mov_b32 s37, s77
    s_mov_b32 s38, 0x100
    s_mov_b32 s39, 0x20000
    s_lshl_b32 s56, s6, 21
    s_add_u32 s96, s56, 0x100000
    s_lshl_b32 s46, s42, 17
    s_add_u32 s56, s56, s46
    s_lshl_b32 s46, s4, 13
    s_add_u32 s56, s56, s46
    s_lshl2_add_u32 s46, s41, s4
    s_lshl_b32 s47, s46, 16
    s_add_u32 s96, s96, s47
    s_lshl4_add_u32 s46, s6, s46
    s_mul_i32 s58, s46, 384
    s_add_u32 s58, s58, 0x2000100
    s_lshl2_add_u32 s46, s42, s4
    s_lshl4_add_u32 s46, s6, s46
    s_mul_i32 s57, s46, 384
    s_add_u32 s57, s57, 0x2000000
    s_mul_i32 s59, s42, 655360
    s_mul_i32 s63, s4, 5120
    s_mov_b32 s44, 0x3e0293ee
    v_lshrrev_b32 v20, 5, v0
    v_bfe_u32 v21, v0, 2, 2
    v_lshl_add_u32 v20, v20, 3, v21
    v_lshlrev_b32 v20, 8, v20
    v_lshl_add_u32 v20, v21, 6, v20
    v_bfe_u32 v22, v0, 4, 1
    v_lshl_add_u32 v20, v22, 5, v20
    v_and_b32 v22, 1, v0
    v_lshl_add_u32 v20, v22, 4, v20
    v_bfe_u32 v22, v0, 1, 1
    v_lshl_add_u32 v20, v22, 3, v20
    v_xor_b32 v5, 0, v20
    v_xor_b32 v6, 64, v20
    v_xor_b32 v7, 128, v20
    v_xor_b32 v8, 192, v20
    v_lshlrev_b32 v13, 4, v0
    s_lshl2_add_u32 s46, s41, s57
    s_lshl2_add_u32 s47, s42, s58
    v_lshlrev_b32 v15, 7, v0
    v_add_u32 v15, s46, v15
    v_writelane_b32 v15, s47, 2
    v_mov_b32 v14, 0
    s_mov_b64 exec, 7
    buffer_store_dword v14, v15, s[32:35], 0 offen sc1
    s_mov_b64 exec, 1
    s_add_u32 s46, s40, 0x200000
    s_mul_i32 s47, s6, 163840
    s_add_u32 s48, s59, 0x280000
    buffer_load_dword v96, v14, s[12:15], s46 offen
    buffer_load_dword v97, v14, s[16:19], s46 offen
    buffer_load_dword v98, v14, s[32:35], s56 offen sc1
    buffer_load_dword v99, v14, s[28:31], s47 offen
    buffer_load_dword v100, v14, s[24:27], s59 offen
    buffer_load_dword v101, v14, s[24:27], s48 offen
    s_mov_b64 exec, -1
    v_and_b32 v14, 31, v0
    v_bfe_u32 v15, v0, 1, 3
    v_lshlrev_b32 v14, 7, v14
    v_lshl_add_u32 v14, v15, 4, v14
    v_lshrrev_b32 v15, 5, v0
    v_lshlrev_b32 v15, 4, v15
    v_xor_b32 v14, v14, v15
    s_lshl_b32 s46, s4, 12
    s_add_u32 s46, s46, 0x24000
    v_add_u32 v14, s46, v14
    v_xor_b32 v212, 0, v14
    v_xor_b32 v213, 32, v14
    v_xor_b32 v214, 64, v14
    v_xor_b32 v215, 96, v14
    v_add_u32 v208, 0x20000, v5
    v_add_u32 v209, 0x20000, v6
    v_add_u32 v210, 0x20000, v7
    v_add_u32 v211, 0x20000, v8
    v_mov_b32 v16, 0
    v_mov_b32 v17, 0
    v_mov_b32 v18, 0
    v_mov_b32 v19, 0
    v_mov_b32 v20, 0
    v_mov_b32 v21, 0
    v_mov_b32 v22, 0
    v_mov_b32 v23, 0
    v_mov_b32 v24, 0
    v_mov_b32 v25, 0
    v_mov_b32 v26, 0
    v_mov_b32 v27, 0
    v_mov_b32 v28, 0
    v_mov_b32 v29, 0
    v_mov_b32 v30, 0
    v_mov_b32 v31, 0
    v_mov_b32 v32, 0
    v_mov_b32 v33, 0
    v_mov_b32 v34, 0
    v_mov_b32 v35, 0
    v_mov_b32 v36, 0
    v_mov_b32 v37, 0
    v_mov_b32 v38, 0
    v_mov_b32 v39, 0
    v_mov_b32 v40, 0
    v_mov_b32 v41, 0
    v_mov_b32 v42, 0
    v_mov_b32 v43, 0
    v_mov_b32 v44, 0
    v_mov_b32 v45, 0
    v_mov_b32 v46, 0
    v_mov_b32 v47, 0
    v_mov_b32 v48, 0
    v_mov_b32 v49, 0
    v_mov_b32 v50, 0
    v_mov_b32 v51, 0
    v_mov_b32 v52, 0
    v_mov_b32 v53, 0
    v_mov_b32 v54, 0
    v_mov_b32 v55, 0
    v_mov_b32 v56, 0
    v_mov_b32 v57, 0
    v_mov_b32 v58, 0
    v_mov_b32 v59, 0
    v_mov_b32 v60, 0
    v_mov_b32 v61, 0
    v_mov_b32 v62, 0
    v_mov_b32 v63, 0
    v_mov_b32 v64, 0
    v_mov_b32 v65, 0
    v_mov_b32 v66, 0
    v_mov_b32 v67, 0
    v_mov_b32 v68, 0
    v_mov_b32 v69, 0
    v_mov_b32 v70, 0
    v_mov_b32 v71, 0
    v_mov_b32 v72, 0
    v_mov_b32 v73, 0
    v_mov_b32 v74, 0
    v_mov_b32 v75, 0
    v_mov_b32 v76, 0
    v_mov_b32 v77, 0
    v_mov_b32 v78, 0
    v_mov_b32 v79, 0
    v_and_b32 v14, 19, v0
    v_bfe_u32 v15, v0, 2, 1
    v_lshl_add_u32 v14, v15, 3, v14
    v_bfe_u32 v15, v0, 3, 1
    v_lshl_add_u32 v14, v15, 2, v14
    v_lshrrev_b32 v15, 5, v0
    v_xor_b32 v15, v15, v14
    v_and_b32 v15, 15, v15
    v_lshlrev_b32 v15, 4, v15
    v_lshl_add_u32 v14, v14, 8, v15
    v_add_u32 v14, 0x0, v14
    v_xor_b32 v224, 0x0, v14
    v_xor_b32 v225, 0x20, v14
    v_xor_b32 v226, 0x40, v14
    v_xor_b32 v227, 0x60, v14
    v_xor_b32 v228, 0x80, v14
    v_xor_b32 v229, 0xa0, v14
    v_xor_b32 v230, 0xc0, v14
    v_xor_b32 v231, 0xe0, v14
    v_add_u32 v232, 0x4000, v5
    v_add_u32 v233, 0x4000, v6
    v_add_u32 v234, 0x4000, v7
    v_add_u32 v235, 0x4000, v8
    s_mov_b32 s54, 0
    s_mul_i32 s46, s4, 20480
    s_mul_i32 s47, s41, 320
    s_add_u32 s46, s46, s47
    s_movk_i32 s47, 3277
    s_movk_i32 s48, 960
    v_add_u32 v14, 0, v0
    v_mul_lo_u32 v15, v14, s47
    v_lshrrev_b32 v15, 16, v15
    v_mul_lo_u32 v15, v15, s48
    v_lshl_add_u32 v15, v14, 4, v15
    v_add_u32 v244, s46, v15
    v_add_u32 v14, 64, v0
    v_mul_lo_u32 v15, v14, s47
    v_lshrrev_b32 v15, 16, v15
    v_mul_lo_u32 v15, v15, s48
    v_lshl_add_u32 v15, v14, 4, v15
    v_add_u32 v245, s46, v15
    v_add_u32 v14, 128, v0
    v_mul_lo_u32 v15, v14, s47
    v_lshrrev_b32 v15, 16, v15
    v_mul_lo_u32 v15, v15, s48
    v_lshl_add_u32 v15, v14, 4, v15
    v_add_u32 v246, s46, v15
    v_add_u32 v14, 192, v0
    v_mul_lo_u32 v15, v14, s47
    v_lshrrev_b32 v15, 16, v15
    v_mul_lo_u32 v15, v15, s48
    v_lshl_add_u32 v15, v14, 4, v15
    v_add_u32 v247, s46, v15
    v_add_u32 v14, 256, v0
    v_mul_lo_u32 v15, v14, s47
    v_lshrrev_b32 v15, 16, v15
    v_mul_lo_u32 v15, v15, s48
    v_lshl_add_u32 v15, v14, 4, v15
    v_add_u32 v248, s46, v15
    v_and_b32 v251, 3, v0
    v_lshlrev_b32 v251, 2, v251
    s_lshl_b32 s46, s6, 4
    v_mov_b32 v252, s46
    s_mov_b32 s98, 0x3e1e3e1e
    s_mov_b32 s99, 0x1e
    s_mov_b32 s43, 10
    s_barrier
    ds_read_b128 v[144:147], v212
    ds_read_b64_tr_b16 v[112:113], v208 offset:0
    ds_read_b64_tr_b16 v[114:115], v208 offset:1024
    ds_read_b64_tr_b16 v[116:117], v209 offset:0
    ds_read_b64_tr_b16 v[118:119], v209 offset:1024
    ds_read_b64_tr_b16 v[120:121], v210 offset:0
    ds_read_b64_tr_b16 v[122:123], v210 offset:1024
    ds_read_b64_tr_b16 v[124:125], v211 offset:0
    ds_read_b64_tr_b16 v[126:127], v211 offset:1024
QP0_LOOP:
    s_waitcnt lgkmcnt(6)
    v_mfma_f32_32x32x16_bf16 v[16:31], v[112:115], v[144:147], v[16:31]
    ds_read_b128 v[148:151], v213
    ds_read_b64_tr_b16 v[128:129], v208 offset:4096
    ds_read_b64_tr_b16 v[130:131], v208 offset:5120
    s_waitcnt lgkmcnt(7)
    v_mfma_f32_32x32x16_bf16 v[32:47], v[116:119], v[144:147], v[32:47]
    ds_read_b64_tr_b16 v[132:133], v209 offset:4096
    ds_read_b64_tr_b16 v[134:135], v209 offset:5120
    ds_read_b64_tr_b16 v[136:137], v210 offset:4096
    s_waitcnt lgkmcnt(8)
    v_mfma_f32_32x32x16_bf16 v[48:63], v[120:123], v[144:147], v[48:63]
    ds_read_b64_tr_b16 v[138:139], v210 offset:5120
    ds_read_b64_tr_b16 v[140:141], v211 offset:4096
    ds_read_b64_tr_b16 v[142:143], v211 offset:5120
    s_waitcnt lgkmcnt(9)
    v_mfma_f32_32x32x16_bf16 v[64:79], v[124:127], v[144:147], v[64:79]
    s_waitcnt lgkmcnt(6)
    v_mfma_f32_32x32x16_bf16 v[16:31], v[128:131], v[148:151], v[16:31]
    ds_read_b128 v[144:147], v214
    ds_read_b64_tr_b16 v[112:113], v208 offset:8192
    ds_read_b64_tr_b16 v[114:115], v208 offset:9216
    s_waitcnt lgkmcnt(7)
    v_mfma_f32_32x32x16_bf16 v[32:47], v[132:135], v[148:151], v[32:47]
    ds_read_b64_tr_b16 v[116:117], v209 offset:8192
    ds_read_b64_tr_b16 v[118:119], v209 offset:9216
    ds_read_b64_tr_b16 v[120:121], v210 offset:8192
    s_waitcnt lgkmcnt(8)
    v_mfma_f32_32x32x16_bf16 v[48:63], v[136:139], v[148:151], v[48:63]
    ds_read_b64_tr_b16 v[122:123], v210 offset:9216
    ds_read_b64_tr_b16 v[124:125], v211 offset:8192
    ds_read_b64_tr_b16 v[126:127], v211 offset:9216
    s_waitcnt lgkmcnt(9)
    v_mfma_f32_32x32x16_bf16 v[64:79], v[140:143], v[148:151], v[64:79]
    s_waitcnt lgkmcnt(6)
    v_mfma_f32_32x32x16_bf16 v[16:31], v[112:115], v[144:147], v[16:31]
    ds_read_b128 v[148:151], v215
    ds_read_b64_tr_b16 v[128:129], v208 offset:12288
    ds_read_b64_tr_b16 v[130:131], v208 offset:13312
    s_waitcnt lgkmcnt(7)
    v_mfma_f32_32x32x16_bf16 v[32:47], v[116:119], v[144:147], v[32:47]
    ds_read_b64_tr_b16 v[132:133], v209 offset:12288
    ds_read_b64_tr_b16 v[134:135], v209 offset:13312
    ds_read_b64_tr_b16 v[136:137], v210 offset:12288
    s_waitcnt lgkmcnt(8)
    v_mfma_f32_32x32x16_bf16 v[48:63], v[120:123], v[144:147], v[48:63]
    ds_read_b64_tr_b16 v[138:139], v210 offset:13312
    ds_read_b64_tr_b16 v[140:141], v211 offset:12288
    ds_read_b64_tr_b16 v[142:143], v211 offset:13312
    s_waitcnt lgkmcnt(9)
    v_mfma_f32_32x32x16_bf16 v[64:79], v[124:127], v[144:147], v[64:79]
    s_bfe_i32 s53, s98, 0x40000
    s_lshl_b32 s53, s53, 15
    s_lshr_b64 s[98:99], s[98:99], 4
    v_add_u32 v208, s53, v208
    v_add_u32 v209, s53, v209
    v_add_u32 v210, s53, v210
    v_add_u32 v211, s53, v211
    v_add_u32 v212, s53, v212
    v_add_u32 v213, s53, v213
    v_add_u32 v214, s53, v214
    v_add_u32 v215, s53, v215
    s_cmp_eq_u32 s43, 1
    s_cbranch_scc0 QP0_NW
    s_waitcnt vmcnt(0)
QP0_NW:
    s_waitcnt lgkmcnt(0)
    s_barrier
    v_mfma_f32_32x32x16_bf16 v[16:31], v[128:131], v[148:151], v[16:31]
    ds_read_b128 v[144:147], v212
    ds_read_b64_tr_b16 v[112:113], v208 offset:0
    ds_read_b64_tr_b16 v[114:115], v208 offset:1024
    v_mfma_f32_32x32x16_bf16 v[32:47], v[132:135], v[148:151], v[32:47]
    ds_read_b64_tr_b16 v[116:117], v209 offset:0
    ds_read_b64_tr_b16 v[118:119], v209 offset:1024
    ds_read_b64_tr_b16 v[120:121], v210 offset:0
    v_mfma_f32_32x32x16_bf16 v[48:63], v[136:139], v[148:151], v[48:63]
    ds_read_b64_tr_b16 v[122:123], v210 offset:1024
    ds_read_b64_tr_b16 v[124:125], v211 offset:0
    ds_read_b64_tr_b16 v[126:127], v211 offset:1024
    v_mfma_f32_32x32x16_bf16 v[64:79], v[140:143], v[148:151], v[64:79]
    s_sub_u32 s43, s43, 1
    s_cmp_lg_u32 s43, 0
    s_cbranch_scc1 QP0_LOOP
    s_waitcnt lgkmcnt(0)
    s_setprio 0
    ds_read_b128 v[176:179], v224 offset:0
    ds_read_b128 v[180:183], v224 offset:8192
    ds_read_b128 v[184:187], v225 offset:0
    ds_read_b128 v[188:191], v225 offset:8192
    ds_read_b128 v[192:195], v226 offset:0
    ds_read_b128 v[196:199], v226 offset:8192
    ds_read_b128 v[200:203], v227 offset:0
    ds_read_b128 v[204:207], v227 offset:8192
    v_mul_f32 v16, s44, v16
    v_mul_f32 v17, s44, v17
    v_mul_f32 v18, s44, v18
    v_mul_f32 v19, s44, v19
    v_cvt_pk_bf16_f32 v80, v16, v17
    v_mul_f32 v20, s44, v20
    v_mul_f32 v21, s44, v21
    v_cvt_pk_bf16_f32 v81, v18, v19
    v_mul_f32 v22, s44, v22
    v_mul_f32 v23, s44, v23
    v_cvt_pk_bf16_f32 v82, v20, v21
    v_mul_f32 v24, s44, v24
    v_mul_f32 v25, s44, v25
    v_cvt_pk_bf16_f32 v83, v22, v23
    v_mul_f32 v26, s44, v26
    v_mul_f32 v27, s44, v27
    v_cvt_pk_bf16_f32 v84, v24, v25
    v_mul_f32 v28, s44, v28
    v_mul_f32 v29, s44, v29
    v_cvt_pk_bf16_f32 v85, v26, v27
    v_mul_f32 v30, s44, v30
    v_mul_f32 v31, s44, v31
    v_cvt_pk_bf16_f32 v86, v28, v29
    v_mul_f32 v32, s44, v32
    v_mul_f32 v33, s44, v33
    v_cvt_pk_bf16_f32 v87, v30, v31
    v_mul_f32 v34, s44, v34
    v_mul_f32 v35, s44, v35
    v_cvt_pk_bf16_f32 v88, v32, v33
    v_mul_f32 v36, s44, v36
    v_mul_f32 v37, s44, v37
    v_cvt_pk_bf16_f32 v89, v34, v35
    v_mul_f32 v38, s44, v38
    v_mul_f32 v39, s44, v39
    v_cvt_pk_bf16_f32 v90, v36, v37
    v_mul_f32 v40, s44, v40
    v_mul_f32 v41, s44, v41
    v_cvt_pk_bf16_f32 v91, v38, v39
    v_mul_f32 v42, s44, v42
    v_mul_f32 v43, s44, v43
    v_cvt_pk_bf16_f32 v92, v40, v41
    v_mul_f32 v44, s44, v44
    v_mul_f32 v45, s44, v45
    v_cvt_pk_bf16_f32 v93, v42, v43
    v_mul_f32 v46, s44, v46
    v_mul_f32 v47, s44, v47
    v_cvt_pk_bf16_f32 v94, v44, v45
    v_mul_f32 v48, s44, v48
    v_mul_f32 v49, s44, v49
    v_cvt_pk_bf16_f32 v95, v46, v47
    v_mul_f32 v50, s44, v50
    v_mul_f32 v51, s44, v51
    v_cvt_pk_bf16_f32 v96, v48, v49
    v_mul_f32 v52, s44, v52
    v_mul_f32 v53, s44, v53
    v_cvt_pk_bf16_f32 v97, v50, v51
    v_mul_f32 v54, s44, v54
    v_mul_f32 v55, s44, v55
    v_cvt_pk_bf16_f32 v98, v52, v53
    v_mul_f32 v56, s44, v56
    v_mul_f32 v57, s44, v57
    v_cvt_pk_bf16_f32 v99, v54, v55
    v_mul_f32 v58, s44, v58
    v_mul_f32 v59, s44, v59
    v_cvt_pk_bf16_f32 v100, v56, v57
    v_mul_f32 v60, s44, v60
    v_mul_f32 v61, s44, v61
    v_cvt_pk_bf16_f32 v101, v58, v59
    v_mul_f32 v62, s44, v62
    v_mul_f32 v63, s44, v63
    v_cvt_pk_bf16_f32 v102, v60, v61
    v_mul_f32 v64, s44, v64
    v_mul_f32 v65, s44, v65
    v_cvt_pk_bf16_f32 v103, v62, v63
    v_mul_f32 v66, s44, v66
    v_mul_f32 v67, s44, v67
    v_cvt_pk_bf16_f32 v104, v64, v65
    v_mul_f32 v68, s44, v68
    v_mul_f32 v69, s44, v69
    v_cvt_pk_bf16_f32 v105, v66, v67
    v_mul_f32 v70, s44, v70
    v_mul_f32 v71, s44, v71
    v_cvt_pk_bf16_f32 v106, v68, v69
    v_mul_f32 v72, s44, v72
    v_mul_f32 v73, s44, v73
    v_cvt_pk_bf16_f32 v107, v70, v71
    v_mul_f32 v74, s44, v74
    v_mul_f32 v75, s44, v75
    v_cvt_pk_bf16_f32 v108, v72, v73
    v_mul_f32 v76, s44, v76
    v_mul_f32 v77, s44, v77
    v_cvt_pk_bf16_f32 v109, v74, v75
    v_mul_f32 v78, s44, v78
    v_mul_f32 v79, s44, v79
    v_cvt_pk_bf16_f32 v110, v76, v77
    v_cvt_pk_bf16_f32 v111, v78, v79
    s_add_u32 s54, s54, 1
    s_cmp_eq_u32 s54, 3
    s_cselect_b32 s54, 0, s54
    s_mov_b32 s53, 0x8000
    s_cselect_b32 s53, 0xffff0000, s53
    s_waitcnt lgkmcnt(7)
    v_mfma_f32_32x32x16_bf16 v[112:127], v[176:179], v[80:83], 0
    ds_read_b128 v[176:179], v228 offset:0
    v_mov_b32 v16, 0
    v_mov_b32 v17, 0
    v_mov_b32 v18, 0
    v_mov_b32 v19, 0
    s_waitcnt lgkmcnt(7)
    v_mfma_f32_32x32x16_bf16 v[128:143], v[180:183], v[80:83], 0
    ds_read_b128 v[180:183], v228 offset:8192
    v_mov_b32 v20, 0
    v_mov_b32 v21, 0
    v_mov_b32 v22, 0
    v_mov_b32 v23, 0
    s_waitcnt lgkmcnt(7)
    v_mfma_f32_32x32x16_bf16 v[112:127], v[184:187], v[84:87], v[112:127]
    ds_read_b128 v[184:187], v229 offset:0
    v_mov_b32 v24, 0
    v_mov_b32 v25, 0
    v_mov_b32 v26, 0
    v_mov_b32 v27, 0
    s_waitcnt lgkmcnt(7)
    v_mfma_f32_32x32x16_bf16 v[128:143], v[188:191], v[84:87], v[128:143]
    ds_read_b128 v[188:191], v229 offset:8192
    v_mov_b32 v28, 0
    v_mov_b32 v29, 0
    v_mov_b32 v30, 0
    v_mov_b32 v31, 0
    s_waitcnt lgkmcnt(7)
    v_mfma_f32_32x32x16_bf16 v[112:127], v[192:195], v[88:91], v[112:127]
    ds_read_b128 v[192:195], v230 offset:0
    v_mov_b32 v32, 0
    v_mov_b32 v33, 0
    v_mov_b32 v34, 0
    v_mov_b32 v35, 0
    s_waitcnt lgkmcnt(7)
    v_mfma_f32_32x32x16_bf16 v[128:143], v[196:199], v[88:91], v[128:143]
    ds_read_b128 v[196:199], v230 offset:8192
    v_mov_b32 v36, 0
    v_mov_b32 v37, 0
    v_mov_b32 v38, 0
    v_mov_b32 v39, 0
    s_waitcnt lgkmcnt(7)
    v_mfma_f32_32x32x16_bf16 v[112:127], v[200:203], v[92:95], v[112:127]
    ds_read_b128 v[200:203], v231 offset:0
    v_mov_b32 v40, 0
    v_mov_b32 v41, 0
    v_mov_b32 v42, 0
    v_mov_b32 v43, 0
    s_waitcnt lgkmcnt(7)
    v_mfma_f32_32x32x16_bf16 v[128:143], v[204:207], v[92:95], v[128:143]
    ds_read_b128 v[204:207], v231 offset:8192
    v_mov_b32 v44, 0
    v_mov_b32 v45, 0
    v_mov_b32 v46, 0
    v_mov_b32 v47, 0
    s_waitcnt lgkmcnt(7)
    v_mfma_f32_32x32x16_bf16 v[112:127], v[176:179], v[96:99], v[112:127]
    v_add_u32 v224, s53, v224
    v_add_u32 v232, s53, v232
    v_mov_b32 v48, 0
    v_mov_b32 v49, 0
    v_mov_b32 v50, 0
    v_mov_b32 v51, 0
    s_waitcnt lgkmcnt(6)
    v_mfma_f32_32x32x16_bf16 v[128:143], v[180:183], v[96:99], v[128:143]
    v_add_u32 v225, s53, v225
    v_add_u32 v233, s53, v233
    v_mov_b32 v52, 0
    v_mov_b32 v53, 0
    v_mov_b32 v54, 0
    v_mov_b32 v55, 0
    s_waitcnt lgkmcnt(5)
    v_mfma_f32_32x32x16_bf16 v[112:127], v[184:187], v[100:103], v[112:127]
    v_add_u32 v226, s53, v226
    v_add_u32 v234, s53, v234
    v_mov_b32 v56, 0
    v_mov_b32 v57, 0
    v_mov_b32 v58, 0
    v_mov_b32 v59, 0
    s_waitcnt lgkmcnt(4)
    v_mfma_f32_32x32x16_bf16 v[128:143], v[188:191], v[100:103], v[128:143]
    v_add_u32 v227, s53, v227
    v_add_u32 v235, s53, v235
    v_mov_b32 v60, 0
    v_mov_b32 v61, 0
    v_mov_b32 v62, 0
    v_mov_b32 v63, 0
    s_waitcnt lgkmcnt(3)
    v_mfma_f32_32x32x16_bf16 v[112:127], v[192:195], v[104:107], v[112:127]
    v_add_u32 v228, s53, v228
    v_mov_b32 v64, 0
    v_mov_b32 v65, 0
    v_mov_b32 v66, 0
    v_mov_b32 v67, 0
    s_waitcnt lgkmcnt(2)
    v_mfma_f32_32x32x16_bf16 v[128:143], v[196:199], v[104:107], v[128:143]
    v_add_u32 v229, s53, v229
    v_mov_b32 v68, 0
    v_mov_b32 v69, 0
    v_mov_b32 v70, 0
    v_mov_b32 v71, 0
    s_waitcnt lgkmcnt(1)
    v_mfma_f32_32x32x16_bf16 v[112:127], v[200:203], v[108:111], v[112:127]
    v_add_u32 v230, s53, v230
    v_mov_b32 v72, 0
    v_mov_b32 v73, 0
    v_mov_b32 v74, 0
    v_mov_b32 v75, 0
    s_waitcnt lgkmcnt(0)
    v_mfma_f32_32x32x16_bf16 v[128:143], v[204:207], v[108:111], v[128:143]
    v_add_u32 v231, s53, v231
    v_mov_b32 v76, 0
    v_mov_b32 v77, 0
    v_mov_b32 v78, 0
    v_mov_b32 v79, 0
    v_mov_b32 v238, 0
    v_mov_b32 v239, 0
    s_mov_b32 s43, 4
    v_max_f32 v236, v112, v113
    s_nop 2
    v_max_f32 v237, v128, v129
    v_max3_f32 v236, v114, v115, v236
    v_max3_f32 v237, v130, v131, v237
    v_max3_f32 v236, v116, v117, v236
    v_max3_f32 v237, v132, v133, v237
    v_max3_f32 v236, v118, v119, v236
    v_max3_f32 v237, v134, v135, v237
    v_max3_f32 v236, v120, v121, v236
    v_max3_f32 v237, v136, v137, v237
    v_max3_f32 v236, v122, v123, v236
    v_max3_f32 v237, v138, v139, v237
    v_max3_f32 v236, v124, v125, v236
    v_max3_f32 v237, v140, v141, v237
    v_max3_f32 v236, v126, v127, v236
    v_max3_f32 v237, v142, v143, v237
    v_max_f32 v236, v236, v237
    s_waitcnt vmcnt(0) lgkmcnt(0)
    s_barrier
    ds_read_b128 v[176:179], v224 offset:0
    ds_read_b128 v[180:183], v224 offset:8192
    ds_read_b128 v[184:187], v225 offset:0
    ds_read_b128 v[188:191], v225 offset:8192
    ds_read_b128 v[192:195], v226 offset:0
    ds_read_b128 v[196:199], v226 offset:8192
    ds_read_b128 v[200:203], v227 offset:0
    ds_read_b128 v[204:207], v227 offset:8192
    v_mov_b32 v237, v236
    s_nop 1
    v_permlane32_swap_b32 v236, v237
    v_max_f32 v236, v236, v237
    v_sub_f32 v208, 0, v236
    v_sub_f32 v209, 0, v236
    v_sub_f32 v210, 0, v236
    v_sub_f32 v211, 0, v236
    v_sub_f32 v212, 0, v236
    v_sub_f32 v213, 0, v236
    v_sub_f32 v214, 0, v236
    v_sub_f32 v215, 0, v236
    v_sub_f32 v216, 0, v236
    v_sub_f32 v217, 0, v236
    v_sub_f32 v218, 0, v236
    v_sub_f32 v219, 0, v236
    v_sub_f32 v220, 0, v236
    v_sub_f32 v221, 0, v236
    v_sub_f32 v222, 0, v236
    v_sub_f32 v223, 0, v236
    v_sub_f32 v112, v112, v236
    v_sub_f32 v113, v113, v236
    v_sub_f32 v114, v114, v236
    v_sub_f32 v115, v115, v236
    v_sub_f32 v116, v116, v236
    v_sub_f32 v117, v117, v236
    v_sub_f32 v118, v118, v236
    v_sub_f32 v119, v119, v236
    v_sub_f32 v120, v120, v236
    v_sub_f32 v121, v121, v236
    v_sub_f32 v122, v122, v236
    v_sub_f32 v123, v123, v236
    v_sub_f32 v124, v124, v236
    v_sub_f32 v125, v125, v236
    v_sub_f32 v126, v126, v236
    v_sub_f32 v127, v127, v236
    v_sub_f32 v128, v128, v236
    v_sub_f32 v129, v129, v236
    v_sub_f32 v130, v130, v236
    v_sub_f32 v131, v131, v236
    v_sub_f32 v132, v132, v236
    v_sub_f32 v133, v133, v236
    v_sub_f32 v134, v134, v236
    v_sub_f32 v135, v135, v236
    v_sub_f32 v136, v136, v236
    v_sub_f32 v137, v137, v236
    v_sub_f32 v138, v138, v236
    v_sub_f32 v139, v139, v236
    v_sub_f32 v140, v140, v236
    v_sub_f32 v141, v141, v236
    v_sub_f32 v142, v142, v236
    v_sub_f32 v143, v143, v236
    s_branch ATT_LOOP
K_END:
    s_endpgm
.section .rodata,"a"
.p2align 6
.amdhsa_kernel standalone__gqa_block_cached__near_ridge_kernel
  .amdhsa_next_free_vgpr 256
  .amdhsa_next_free_sgpr 102
  .amdhsa_accum_offset 256
  .amdhsa_group_segment_fixed_size 0
  .amdhsa_kernarg_size 64
  .amdhsa_user_sgpr_count 2
  .amdhsa_user_sgpr_kernarg_segment_ptr 1
  .amdhsa_system_sgpr_workgroup_id_x 1
.end_amdhsa_kernel
```
